```python
import torch

def _softmax(x, axis=-1):
    return torch.softmax(x, dim=axis)
def _gelu(x):
    return torch.nn.functional.gelu(x, approximate="tanh")
def _silu(x):
    return torch.nn.functional.silu(x)
def _sigmoid(x):
    return torch.sigmoid(x)
def _layernorm(x, axis=-1, eps=1e-5):
    m = x.mean(dim=axis, keepdim=True)
    v = x.var(dim=axis, keepdim=True, unbiased=False)
    return (x - m) / torch.sqrt(v + eps)
def _scatter_add(tgt, idx, src, axis=0):
    return tgt.clone().index_add_(axis, idx, src)
def _segment_sum(src, seg, n):
    out = torch.zeros((n,) + src.shape[1:], dtype=src.dtype)
    return out.index_add_(0, seg, src)
def _pad(x, pw):
    flat = tuple(v for pair in reversed(pw) for v in pair)
    return torch.nn.functional.pad(x, flat)

kernel_name = 'standalone__fused_io_aware_attn__prompt'

def setup_inputs():

    _w = (lambda a: (lambda t: t.to(torch.bfloat16) if t.is_floating_point() else t)(torch.as_tensor(a)))
    B, H, S = 2, 32, 2048
    Dh = max(1, 576 // 32)
    return {
        "q": _w((lambda *s: torch.randn(*s, dtype=torch.bfloat16) * 0.8)(B, H, S, Dh)),
        "k": _w((lambda *s: torch.randn(*s, dtype=torch.bfloat16) * 0.8)(B, H, S, Dh)),
        "v": _w((lambda *s: torch.randn(*s, dtype=torch.bfloat16) * 0.05)(B, H, S, Dh)),
    }

def reference(q, k, v):
    scale = q.shape[-1] ** -0.5
    s = torch.einsum('bhqd,bhkd->bhqk', q, k) * scale
    p = _softmax(s, axis=-1)
    return torch.einsum('bhqk,bhkd->bhqd', p, v)
```

```asm
; @launch grid=(256,1,1) block=(512,1,1) lds=155648
.amdgcn_target "amdgcn-amd-amdhsa--gfx950"
.text
.globl standalone__fused_io_aware_attn__prompt_kernel
.p2align 12
.p2align 8
.type standalone__fused_io_aware_attn__prompt_kernel,@function
standalone__fused_io_aware_attn__prompt_kernel:
    s_load_dwordx8 s[4:11], s[0:1], 0
    s_cmp_ge_u32 s2, 256
    s_cbranch_scc1 L_end0
    v_lshrrev_b32 v162, 6, v0
    v_and_b32 v0, 63, v0
    v_readfirstlane_b32 s32, v162
    s_and_b32 s3, s2, 7
    s_lshl_b32 s3, s3, 3
    s_lshr_b32 s33, s2, 5
    s_add_u32 s3, s3, s33
    s_mul_i32 s3, s3, 73728
    s_bfe_u32 s82, s2, 0x20003
    s_lshl_b32 s82, s82, 3
    s_add_u32 s82, s82, s32
    s_mul_i32 s82, s82, 2304
    s_add_u32 s82, s82, s3
    s_and_b32 s80, s32, 3
    s_lshr_b32 s81, s32, 2
    s_mul_i32 s81, s81, 4608
    s_cmp_lt_u32 s32, 4
    s_cbranch_scc1 L_notouch
    s_mov_b64 exec, 0
    s_cmp_eq_u32 s80, 0
    s_cbranch_scc1 L_t1
    s_cmp_eq_u32 s80, 1
    s_cbranch_scc1 L_t2
    s_cmp_eq_u32 s80, 2
    s_cbranch_scc1 L_t3
    s_branch L_t4
L_ret:
    s_mov_b64 exec, -1
L_notouch:
    v_and_b32 v162, 31, v0
    v_lshrrev_b32 v163, 5, v0
    v_mul_u32_u24 v156, 36, v162
    v_lshl_add_u32 v156, v163, 4, v156
    v_mad_u32_u24 v157, v0, 36, 28
    s_mul_i32 s34, s80, 1152
    v_add_u32 v158, s34, v156
    v_lshrrev_b32 v164, 1, v0
    v_and_b32 v165, 1, v0
    v_mul_u32_u24 v159, 36, v164
    v_lshl_add_u32 v159, v165, 4, v159
    v_add_u32 v159, s34, v159
    s_and_b32 s36, s32, 1
    s_mul_i32 s35, s36, 2304
    v_add_u32 v160, s35, v157
    s_lshl_b32 s34, s32, 10
    s_lshr_b32 s35, s32, 1
    s_mul_i32 s35, s35, 2816
    s_mul_i32 s36, s36, 1280
    s_add_u32 s35, s35, s36
    s_add_u32 s35, s35, 65536
    s_mov_b32 s15, 0x00020000
    s_mov_b32 s19, 0x00020000
    s_mov_b32 s23, 0x00020000
    s_mov_b32 s27, 0x00020000
    s_mov_b32 s31, 0x00020000
    s_movk_i32 s14, 2304
    s_movk_i32 s26, 2304
    s_mov_b32 s18, 73728
    s_mov_b32 s22, s18
    s_mov_b32 s30, s18
    s_cmp_lt_u32 s32, 4
    s_cbranch_scc1 L_a1
    s_waitcnt lgkmcnt(0)
    s_add_u32 s16, s6, s3
    s_addc_u32 s17, s7, 0
    s_add_u32 s20, s8, s3
    s_addc_u32 s21, s9, 0
    s_cmp_lt_u32 s80, 2
    s_cselect_b32 s28, s16, s20
    s_cselect_b32 s29, s17, s21
    s_add_u32 s12, s4, s82
    s_addc_u32 s13, s5, 0
    s_add_u32 m0, s34, 0
    s_add_u32 s33, s81, 0
    buffer_load_dwordx4 v158, s[16:19], s33 offen lds
    buffer_load_dword v148, v160, s[28:31], s33 offen offset:4
    s_add_u32 m0, s35, 0
    s_nop 0
    buffer_load_dwordx4 v159, s[20:23], s33 offen lds
    s_branch L_c
L_b2:
    s_waitcnt lgkmcnt(0)
    s_barrier
    buffer_load_dword v187, v157, s[12:15], 0 offen offset:4
    buffer_load_dwordx4 v[112:115], v156, s[12:15], 0 offen
    buffer_load_dwordx4 v[116:119], v156, s[12:15], 0 offen offset:1152
    s_setprio 3
    s_waitcnt vmcnt(4)
    ds_write_b32 v12, v148 offset:0
    s_waitcnt vmcnt(3) lgkmcnt(0)
    s_barrier
    s_branch L_main
L_end0:
    s_endpgm
L_a1:
    s_mov_b32 m0, s34
    s_waitcnt lgkmcnt(0)
    s_add_u32 s16, s6, s3
    s_addc_u32 s17, s7, 0
    buffer_load_dwordx4 v158, s[16:19], 0 offen lds
    s_add_u32 s20, s8, s3
    s_addc_u32 s21, s9, 0
    s_cmp_lt_u32 s80, 2
    s_cselect_b32 s28, s16, s20
    s_cselect_b32 s29, s17, s21
    buffer_load_dword v148, v160, s[28:31], 0 offen offset:4
    s_mov_b32 m0, s35
    s_nop 0
    buffer_load_dwordx4 v159, s[20:23], 0 offen lds
    s_add_u32 s12, s4, s82
    s_addc_u32 s13, s5, 0
    buffer_load_dword v187, v157, s[12:15], 0 offen offset:4
    buffer_load_dwordx4 v[112:115], v156, s[12:15], 0 offen
    buffer_load_dwordx4 v[116:119], v156, s[12:15], 0 offen offset:1152
    s_setprio 1
L_c:
    s_add_u32 s24, s10, s82
    s_addc_u32 s25, s11, 0
    v_lshlrev_b32 v1, 4, v0
    s_mov_b32 s3, 68096
    v_lshl_add_u32 v2, v0, 2, s3
    v_add_u32 v3, 45056, v2
    v_mul_u32_u24 v166, 1280, v163
    v_and_b32 v167, 3, v0
    v_lshl_add_u32 v166, v167, 3, v166
    v_bfe_u32 v167, v0, 3, 2
    v_lshl_add_u32 v166, v167, 5, v166
    v_bfe_u32 v167, v0, 2, 1
    v_lshlrev_b32 v167, 7, v167
    v_sub_u32 v166, v166, v167
    v_add_u32 v166, 66688, v166
    s_mul_i32 s3, s32, 11264
    v_add_u32 v167, s3, v166
    v_mov_b32 v123, 0x3f80
    ds_write_b32 v167, v123 offset:4
    ds_write_b32 v167, v123 offset:2820
    ds_write_b32 v167, v123 offset:5636
    ds_write_b32 v167, v123 offset:8452
    s_cmp_lt_u32 s80, 2
    s_cselect_b64 vcc, -1, 0
    s_and_b32 s3, s32, 1
    s_mul_i32 s3, s3, 2816
    v_cndmask_b32 v166, v166, v2, vcc
    s_lshr_b32 s37, s32, 2
    s_mul_i32 s37, s37, 5632
    s_add_u32 s3, s3, s37
    v_add_u32 v12, s3, v166
    v_add_u32 v13, 45056, v12
    v_bfe_u32 v166, v0, 2, 2
    v_lshl_add_u32 v167, v163, 3, v166
    v_lshlrev_b32 v167, 5, v167
    v_lshl_add_u32 v167, v165, 4, v167
    v_bfe_u32 v168, v0, 1, 1
    v_lshl_add_u32 v167, v168, 3, v167
    v_lshl_add_u32 v168, v163, 2, v166
    v_lshlrev_b32 v168, 3, v168
    v_add_u32 v168, 1152, v168
    v_and_b32 v169, 16, v0
    v_cmp_eq_u32 vcc, 0, v169
    v_mov_b32 v169, 0x200
    v_mov_b32 v170, 0x80
    v_cndmask_b32 v167, v168, v167, vcc
    v_cndmask_b32 v169, 64, v169, vcc
    v_mov_b32 v168, 0xffffff80
    v_cndmask_b32 v170, v168, v170, vcc
    v_and_b32 v168, 19, v0
    v_cmp_lt_u32 vcc, 0x10, v168
    v_mov_b32 v168, 0x18000
    v_mov_b32 v14, 0xdddd
    v_cndmask_b32 v167, v167, v168, vcc
    v_add_u32 v4, 65536, v167
    v_add_u32 v5, v4, v170
    v_add_u32 v6, v4, v169
    v_add_u32 v7, v6, v170
    v_add_u32 v8, 45056, v4
    v_add_u32 v9, 45056, v5
    v_add_u32 v10, 45056, v6
    v_add_u32 v11, 45056, v7
    v_mov_b32 v121, 0x4286
    s_mov_b32 s36, 0x3eae1a93
    s_mov_b32 s37, 0
    s_mul_i32 s3, s32, 2304
    v_add_u32 v180, s3, v156
    v_add_u32 v181, 1152, v180
    v_add_u32 v166, s3, v157
    v_cmp_gt_u32 vcc, 32, v0
    v_add_u32 v183, s3, v1
    v_mov_b32 v167, 0x28000
    v_cndmask_b32 v182, v167, v166, vcc
    v_lshlrev_b32 v185, 2, v0
    s_add_u32 s3, s3, 2048
    v_add_u32 v184, s3, v185
    v_pk_mov_b32 v[80:81], 0, 0
    v_pk_mov_b32 v[82:83], 0, 0
    v_pk_mov_b32 v[84:85], 0, 0
    v_pk_mov_b32 v[86:87], 0, 0
    v_pk_mov_b32 v[88:89], 0, 0
    v_pk_mov_b32 v[90:91], 0, 0
    v_pk_mov_b32 v[92:93], 0, 0
    v_pk_mov_b32 v[94:95], 0, 0
    v_pk_mov_b32 v[96:97], 0, 0
    v_pk_mov_b32 v[98:99], 0, 0
    v_pk_mov_b32 v[100:101], 0, 0
    v_pk_mov_b32 v[102:103], 0, 0
    v_pk_mov_b32 v[104:105], 0, 0
    v_pk_mov_b32 v[106:107], 0, 0
    v_pk_mov_b32 v[108:109], 0, 0
    v_pk_mov_b32 v[110:111], 0, 0
    s_cmp_ge_u32 s32, 4
    s_cbranch_scc1 L_b2
    s_waitcnt vmcnt(4)
    ds_write_b32 v12, v148 offset:0
    s_waitcnt vmcnt(3) lgkmcnt(0)
    s_barrier
L_main:
    ds_read_b32 v122, v2 offset:0
    ds_read_b128 v[124:127], v1 offset:0
    ds_read_b128 v[128:131], v1 offset:1024
    ds_read_b64_tr_b16 v[132:133], v4 offset:0
    ds_read_b64_tr_b16 v[134:135], v5 offset:0
    ds_read_b64_tr_b16 v[140:141], v6 offset:0
    ds_read_b64_tr_b16 v[142:143], v7 offset:0
    s_waitcnt vmcnt(2)
    v_lshlrev_b32 v162, 16, v187
    v_and_b32 v163, 0xffff0000, v187
    v_mul_f32 v162, s36, v162
    v_mul_f32 v163, s36, v163
    v_cvt_pk_bf16_f32 v120, v162, v163
    s_nop 0
    s_waitcnt lgkmcnt(6)
    v_mfma_f32_32x32x4_2b_bf16 v[16:47], v[122:123], v[120:121], 0 cbsz:1 abid:0
    s_waitcnt vmcnt(1)
    v_lshlrev_b32 v162, 16, v112
    v_and_b32 v163, 0xffff0000, v112
    v_mul_f32 v162, s36, v162
    v_mul_f32 v163, s36, v163
    v_cvt_pk_bf16_f32 v112, v162, v163
    v_lshlrev_b32 v164, 16, v113
    v_and_b32 v165, 0xffff0000, v113
    v_mul_f32 v164, s36, v164
    v_mul_f32 v165, s36, v165
    v_cvt_pk_bf16_f32 v113, v164, v165
    v_lshlrev_b32 v166, 16, v114
    v_and_b32 v167, 0xffff0000, v114
    v_mul_f32 v166, s36, v166
    v_mul_f32 v167, s36, v167
    v_cvt_pk_bf16_f32 v114, v166, v167
    v_lshlrev_b32_e64 v168, 16, v115
    v_and_b32 v169, 0xffff0000, v115
    v_mul_f32 v168, s36, v168
    v_mul_f32 v169, s36, v169
    v_cvt_pk_bf16_f32 v115, v168, v169
    s_nop 0
    s_waitcnt lgkmcnt(0)
    v_mfma_f32_32x32x16_bf16 v[16:31], v[124:127], v[112:115], v[16:31]
    s_waitcnt vmcnt(0)
    v_lshlrev_b32 v162, 16, v116
    v_and_b32 v163, 0xffff0000, v116
    v_mul_f32 v162, s36, v162
    v_mul_f32 v163, s36, v163
    v_cvt_pk_bf16_f32 v116, v162, v163
    v_lshlrev_b32 v164, 16, v117
    v_and_b32 v165, 0xffff0000, v117
    v_mul_f32 v164, s36, v164
    v_mul_f32_e64 v165, s36, v165
    v_cvt_pk_bf16_f32 v117, v164, v165
    v_lshlrev_b32 v166, 16, v118
    v_and_b32 v167, 0xffff0000, v118
    v_mul_f32 v166, s36, v166
    v_mul_f32_e64 v167, s36, v167
    v_cvt_pk_bf16_f32 v118, v166, v167
    v_lshlrev_b32 v168, 16, v119
    v_and_b32 v169, 0xffff0000, v119
    v_mul_f32 v168, s36, v168
    v_mul_f32_e64 v169, s36, v169
    v_cvt_pk_bf16_f32 v119, v168, v169
    s_cmp_ge_u32 s32, 4
    s_nop 0
    v_mfma_f32_32x32x16_bf16 v[32:47], v[124:127], v[116:119], v[32:47]
L_tiles:
    v_exp_f32 v16, v16
    v_exp_f32 v17, v17
    v_exp_f32 v18, v18
    ds_read_b64_tr_b16 v[144:145], v6 offset:1280
    ds_read_b64_tr_b16 v[146:147], v7 offset:1280
    v_exp_f32 v19, v19
    v_exp_f32 v20, v20
    v_exp_f32 v21, v21
    v_exp_f32 v22, v22
    v_mfma_f32_32x32x4_2b_bf16 v[48:79], v[122:123], v[120:121], 0 cbsz:1 abid:1
    v_exp_f32 v23, v23
    v_exp_f32 v24, v24
    v_exp_f32 v25, v25
    v_exp_f32 v26, v26
    v_exp_f32 v27, v27
    v_exp_f32 v28, v28
    v_exp_f32 v29, v29
    v_exp_f32 v30, v30
    v_exp_f32 v31, v31
    v_smfmac_f32_32x32x32_bf16 v[80:95], v[132:135], v[16:23], v14
    s_add_u32 m0, s34, 8192
    s_add_u32 s33, s81, 9216
    buffer_load_dwordx4 v158, s[16:19], s33 offen lds
    v_exp_f32 v32, v32
    v_exp_f32 v33, v33
    v_exp_f32 v34, v34
    v_smfmac_f32_32x32x32_bf16 v[80:95], v[140:143], v[24:31], v14
    ds_read_b128 v[124:127], v1 offset:2048
    ds_read_b32 v122, v2 offset:2816
    v_exp_f32 v35, v35
    v_exp_f32 v36, v36
    v_exp_f32 v37, v37
    v_exp_f32 v38, v38
    v_exp_f32 v39, v39
    v_mfma_f32_32x32x16_bf16 v[48:63], v[128:131], v[112:115], v[48:63]
    ds_read_b64_tr_b16 v[136:137], v4 offset:1280
    ds_read_b64_tr_b16 v[138:139], v5 offset:1280
    v_exp_f32 v40, v40
    v_exp_f32 v41, v41
    v_exp_f32 v42, v42
    v_exp_f32 v43, v43
    v_mfma_f32_32x32x16_bf16 v[64:79], v[128:131], v[116:119], v[64:79]
    v_exp_f32 v44, v44
    v_exp_f32 v45, v45
    v_exp_f32 v46, v46
    v_smfmac_f32_32x32x32_bf16 v[96:111], v[132:135], v[32:39], v14
    s_waitcnt lgkmcnt(0)
    v_exp_f32 v47, v47
    v_exp_f32 v48, v48
    v_exp_f32 v49, v49
    v_exp_f32 v50, v50
    v_smfmac_f32_32x32x32_bf16 v[96:111], v[140:143], v[40:47], v14
    ds_read_b64_tr_b16 v[140:141], v6 offset:2816
    ds_read_b64_tr_b16 v[142:143], v7 offset:2816
    v_exp_f32 v51, v51
    v_exp_f32 v52, v52
    v_exp_f32 v53, v53
    v_exp_f32 v54, v54
    v_mfma_f32_32x32x4_2b_bf16 v[16:47], v[122:123], v[120:121], 0 cbsz:1 abid:0
    v_exp_f32 v55, v55
    v_exp_f32 v56, v56
    v_exp_f32 v57, v57
    v_exp_f32 v58, v58
    v_exp_f32 v59, v59
    v_exp_f32 v60, v60
    v_exp_f32 v61, v61
    v_exp_f32 v62, v62
    v_exp_f32 v63, v63
    v_smfmac_f32_32x32x32_bf16 v[80:95], v[136:139], v[48:55], v14
    buffer_load_dword v149, v160, s[28:31], s33 offen offset:4
    v_exp_f32 v64, v64
    v_exp_f32 v65, v65
    v_exp_f32 v66, v66
    v_smfmac_f32_32x32x32_bf16 v[80:95], v[144:147], v[56:63], v14
    s_cmp_ge_u32 s32, 4
    s_cbranch_scc1 L_nb
    s_barrier
L_nb:
    ds_read_b128 v[128:131], v1 offset:3072
    v_exp_f32 v67, v67
    v_exp_f32 v68, v68
    v_exp_f32 v69, v69
    v_exp_f32 v70, v70
    v_exp_f32 v71, v71
    v_mfma_f32_32x32x16_bf16 v[16:31], v[124:127], v[112:115], v[16:31]
    ds_read_b64_tr_b16 v[132:133], v4 offset:2816
    ds_read_b64_tr_b16 v[134:135], v5 offset:2816
    v_exp_f32 v72, v72
    v_exp_f32 v73, v73
    v_exp_f32 v74, v74
    v_exp_f32 v75, v75
    v_mfma_f32_32x32x16_bf16 v[32:47], v[124:127], v[116:119], v[32:47]
    v_exp_f32 v76, v76
    v_exp_f32 v77, v77
    v_exp_f32 v78, v78
    v_smfmac_f32_32x32x32_bf16 v[96:111], v[136:139], v[64:71], v14
    s_waitcnt lgkmcnt(0)
    v_exp_f32 v79, v79
    v_exp_f32 v16, v16
    v_exp_f32 v17, v17
    v_exp_f32 v18, v18
    v_smfmac_f32_32x32x32_bf16 v[96:111], v[144:147], v[72:79], v14
    ds_read_b64_tr_b16 v[144:145], v6 offset:4096
    ds_read_b64_tr_b16 v[146:147], v7 offset:4096
    v_exp_f32 v19, v19
    v_exp_f32 v20, v20
    v_exp_f32 v21, v21
    v_exp_f32 v22, v22
    v_mfma_f32_32x32x4_2b_bf16 v[48:79], v[122:123], v[120:121], 0 cbsz:1 abid:1
    v_exp_f32 v23, v23
    v_exp_f32 v24, v24
    v_exp_f32 v25, v25
    v_exp_f32 v26, v26
    v_exp_f32 v27, v27
    v_exp_f32 v28, v28
    v_exp_f32 v29, v29
    v_exp_f32 v30, v30
    v_exp_f32 v31, v31
    v_smfmac_f32_32x32x32_bf16 v[80:95], v[132:135], v[16:23], v14
    s_add_u32 m0, s35, 11264
    s_nop 0
    buffer_load_dwordx4 v159, s[20:23], s33 offen lds
    v_exp_f32 v32, v32
    v_exp_f32 v33, v33
    v_exp_f32 v34, v34
    v_smfmac_f32_32x32x32_bf16 v[80:95], v[140:143], v[24:31], v14
    ds_read_b128 v[124:127], v1 offset:4096
    ds_read_b32 v122, v2 offset:5632
    v_exp_f32 v35, v35
    v_exp_f32 v36, v36
    v_exp_f32 v37, v37
    v_exp_f32 v38, v38
    v_exp_f32 v39, v39
    v_mfma_f32_32x32x16_bf16 v[48:63], v[128:131], v[112:115], v[48:63]
    ds_read_b64_tr_b16 v[136:137], v4 offset:4096
    ds_read_b64_tr_b16 v[138:139], v5 offset:4096
    v_exp_f32 v40, v40
    v_exp_f32 v41, v41
    v_exp_f32 v42, v42
    v_exp_f32 v43, v43
    v_mfma_f32_32x32x16_bf16 v[64:79], v[128:131], v[116:119], v[64:79]
    v_exp_f32 v44, v44
    v_exp_f32 v45, v45
    v_exp_f32 v46, v46
    v_smfmac_f32_32x32x32_bf16 v[96:111], v[132:135], v[32:39], v14
    s_waitcnt lgkmcnt(0)
    v_exp_f32 v47, v47
    v_exp_f32 v48, v48
    v_exp_f32 v49, v49
    v_exp_f32 v50, v50
    v_smfmac_f32_32x32x32_bf16 v[96:111], v[140:143], v[40:47], v14
    ds_read_b64_tr_b16 v[140:141], v6 offset:5632
    ds_read_b64_tr_b16 v[142:143], v7 offset:5632
    v_exp_f32 v51, v51
    v_exp_f32 v52, v52
    v_exp_f32 v53, v53
    v_exp_f32 v54, v54
    v_mfma_f32_32x32x4_2b_bf16 v[16:47], v[122:123], v[120:121], 0 cbsz:1 abid:0
    v_exp_f32 v55, v55
    v_exp_f32 v56, v56
    v_exp_f32 v57, v57
    v_exp_f32 v58, v58
    v_exp_f32 v59, v59
    v_exp_f32 v60, v60
    v_exp_f32 v61, v61
    v_exp_f32 v62, v62
    v_exp_f32 v63, v63
    v_smfmac_f32_32x32x32_bf16 v[80:95], v[136:139], v[48:55], v14
    s_add_u32 m0, s34, 16384
    s_add_u32 s33, s81, 18432
    buffer_load_dwordx4 v158, s[16:19], s33 offen lds
    v_exp_f32 v64, v64
    v_exp_f32 v65, v65
    v_exp_f32 v66, v66
    v_smfmac_f32_32x32x32_bf16 v[80:95], v[144:147], v[56:63], v14
    ds_read_b128 v[128:131], v1 offset:5120
    v_exp_f32 v67, v67
    v_exp_f32 v68, v68
    v_exp_f32 v69, v69
    v_exp_f32 v70, v70
    v_exp_f32 v71, v71
    v_mfma_f32_32x32x16_bf16 v[16:31], v[124:127], v[112:115], v[16:31]
    ds_read_b64_tr_b16 v[132:133], v4 offset:5632
    ds_read_b64_tr_b16 v[134:135], v5 offset:5632
    v_exp_f32 v72, v72
    v_exp_f32 v73, v73
    v_exp_f32 v74, v74
    v_exp_f32 v75, v75
    v_mfma_f32_32x32x16_bf16 v[32:47], v[124:127], v[116:119], v[32:47]
    v_exp_f32 v76, v76
    v_exp_f32 v77, v77
    v_exp_f32 v78, v78
    v_smfmac_f32_32x32x32_bf16 v[96:111], v[136:139], v[64:71], v14
    s_waitcnt lgkmcnt(0)
    v_exp_f32 v79, v79
    v_exp_f32 v16, v16
    v_exp_f32 v17, v17
    v_exp_f32 v18, v18
    v_smfmac_f32_32x32x32_bf16 v[96:111], v[144:147], v[72:79], v14
    ds_read_b64_tr_b16 v[144:145], v6 offset:6912
    ds_read_b64_tr_b16 v[146:147], v7 offset:6912
    v_exp_f32 v19, v19
    v_exp_f32 v20, v20
    v_exp_f32 v21, v21
    v_exp_f32 v22, v22
    v_mfma_f32_32x32x4_2b_bf16 v[48:79], v[122:123], v[120:121], 0 cbsz:1 abid:1
    v_exp_f32 v23, v23
    v_exp_f32 v24, v24
    v_exp_f32 v25, v25
    v_exp_f32 v26, v26
    v_exp_f32 v27, v27
    v_exp_f32 v28, v28
    v_exp_f32 v29, v29
    v_exp_f32 v30, v30
    v_exp_f32 v31, v31
    v_smfmac_f32_32x32x32_bf16 v[80:95], v[132:135], v[16:23], v14
    buffer_load_dword v150, v160, s[28:31], s33 offen offset:4
    v_exp_f32 v32, v32
    v_exp_f32 v33, v33
    v_exp_f32 v34, v34
    v_smfmac_f32_32x32x32_bf16 v[80:95], v[140:143], v[24:31], v14
    ds_read_b128 v[124:127], v1 offset:6144
    ds_read_b32 v122, v2 offset:8448
    v_exp_f32 v35, v35
    v_exp_f32 v36, v36
    v_exp_f32 v37, v37
    v_exp_f32 v38, v38
    v_exp_f32 v39, v39
    v_mfma_f32_32x32x16_bf16 v[48:63], v[128:131], v[112:115], v[48:63]
    ds_read_b64_tr_b16 v[136:137], v4 offset:6912
    ds_read_b64_tr_b16 v[138:139], v5 offset:6912
    v_exp_f32 v40, v40
    v_exp_f32 v41, v41
    v_exp_f32 v42, v42
    v_exp_f32 v43, v43
    v_mfma_f32_32x32x16_bf16 v[64:79], v[128:131], v[116:119], v[64:79]
    v_exp_f32 v44, v44
    v_exp_f32 v45, v45
    v_exp_f32 v46, v46
    v_smfmac_f32_32x32x32_bf16 v[96:111], v[132:135], v[32:39], v14
    s_waitcnt lgkmcnt(0)
    v_exp_f32 v47, v47
    v_exp_f32 v48, v48
    v_exp_f32 v49, v49
    v_exp_f32 v50, v50
    v_smfmac_f32_32x32x32_bf16 v[96:111], v[140:143], v[40:47], v14
    ds_read_b64_tr_b16 v[140:141], v6 offset:8448
    ds_read_b64_tr_b16 v[142:143], v7 offset:8448
    v_exp_f32 v51, v51
    v_exp_f32 v52, v52
    v_exp_f32 v53, v53
    v_exp_f32 v54, v54
    v_mfma_f32_32x32x4_2b_bf16 v[16:47], v[122:123], v[120:121], 0 cbsz:1 abid:0
    v_exp_f32 v55, v55
    v_exp_f32 v56, v56
    v_exp_f32 v57, v57
    v_exp_f32 v58, v58
    v_exp_f32 v59, v59
    v_exp_f32 v60, v60
    v_exp_f32 v61, v61
    v_exp_f32 v62, v62
    v_exp_f32 v63, v63
    v_smfmac_f32_32x32x32_bf16 v[80:95], v[136:139], v[48:55], v14
    s_add_u32 m0, s35, 22528
    s_nop 0
    buffer_load_dwordx4 v159, s[20:23], s33 offen lds
    v_exp_f32 v64, v64
    v_exp_f32 v65, v65
    v_exp_f32 v66, v66
    v_smfmac_f32_32x32x32_bf16 v[80:95], v[144:147], v[56:63], v14
    s_setprio 1
    ds_read_b128 v[128:131], v1 offset:7168
    v_exp_f32 v67, v67
    v_exp_f32 v68, v68
    v_exp_f32 v69, v69
    v_exp_f32 v70, v70
    v_exp_f32 v71, v71
    v_mfma_f32_32x32x16_bf16 v[16:31], v[124:127], v[112:115], v[16:31]
    ds_read_b64_tr_b16 v[132:133], v4 offset:8448
    ds_read_b64_tr_b16 v[134:135], v5 offset:8448
    v_exp_f32 v72, v72
    v_exp_f32 v73, v73
    v_exp_f32 v74, v74
    v_exp_f32 v75, v75
    v_mfma_f32_32x32x16_bf16 v[32:47], v[124:127], v[116:119], v[32:47]
    s_waitcnt vmcnt(3)
    ds_write_b32 v12, v149 offset:11264
    v_exp_f32 v76, v76
    v_exp_f32 v77, v77
    v_exp_f32 v78, v78
    v_smfmac_f32_32x32x32_bf16 v[96:111], v[136:139], v[64:71], v14
    s_waitcnt lgkmcnt(0)
    v_exp_f32 v79, v79
    v_exp_f32 v16, v16
    v_exp_f32 v17, v17
    v_exp_f32 v18, v18
    v_smfmac_f32_32x32x32_bf16 v[96:111], v[144:147], v[72:79], v14
    s_setprio 0
    ds_read_b64_tr_b16 v[144:145], v6 offset:9728
    ds_read_b64_tr_b16 v[146:147], v7 offset:9728
    v_exp_f32 v19, v19
    v_exp_f32 v20, v20
    v_exp_f32 v21, v21
    v_exp_f32 v22, v22
    v_mfma_f32_32x32x4_2b_bf16 v[48:79], v[122:123], v[120:121], 0 cbsz:1 abid:1
    v_exp_f32 v23, v23
    v_exp_f32 v24, v24
    v_exp_f32 v25, v25
    v_exp_f32 v26, v26
    v_exp_f32 v27, v27
    v_exp_f32 v28, v28
    v_exp_f32 v29, v29
    v_exp_f32 v30, v30
    v_exp_f32 v31, v31
    v_smfmac_f32_32x32x32_bf16 v[80:95], v[132:135], v[16:23], v14
    s_add_u32 m0, s34, 24576
    s_add_u32 s33, s81, 27648
    buffer_load_dwordx4 v158, s[16:19], s33 offen lds
    v_exp_f32 v32, v32
    v_exp_f32 v33, v33
    v_exp_f32 v34, v34
    v_smfmac_f32_32x32x32_bf16 v[80:95], v[140:143], v[24:31], v14
    s_barrier
    s_setprio 3
    ds_read_b128 v[124:127], v1 offset:8192
    ds_read_b32 v122, v2 offset:11264
    v_exp_f32 v35, v35
    v_exp_f32 v36, v36
    v_exp_f32 v37, v37
    v_exp_f32 v38, v38
    v_exp_f32 v39, v39
    v_mfma_f32_32x32x16_bf16 v[48:63], v[128:131], v[112:115], v[48:63]
    ds_read_b64_tr_b16 v[136:137], v4 offset:9728
    ds_read_b64_tr_b16 v[138:139], v5 offset:9728
    v_exp_f32 v40, v40
    v_exp_f32 v41, v41
    v_exp_f32 v42, v42
    v_exp_f32 v43, v43
    v_mfma_f32_32x32x16_bf16 v[64:79], v[128:131], v[116:119], v[64:79]
L_t1:
    s_cbranch_execz L_ret
    v_exp_f32 v44, v44
    v_exp_f32 v45, v45
    v_exp_f32 v46, v46
    v_smfmac_f32_32x32x32_bf16 v[96:111], v[132:135], v[32:39], v14
    s_waitcnt lgkmcnt(0)
    v_exp_f32 v47, v47
    v_exp_f32 v48, v48
    v_exp_f32 v49, v49
    v_exp_f32 v50, v50
    v_smfmac_f32_32x32x32_bf16 v[96:111], v[140:143], v[40:47], v14
    ds_read_b64_tr_b16 v[140:141], v6 offset:11264
    ds_read_b64_tr_b16 v[142:143], v7 offset:11264
    v_exp_f32 v51, v51
    v_exp_f32 v52, v52
    v_exp_f32 v53, v53
    v_exp_f32 v54, v54
    v_mfma_f32_32x32x4_2b_bf16 v[16:47], v[122:123], v[120:121], 0 cbsz:1 abid:0
    v_exp_f32 v55, v55
    v_exp_f32 v56, v56
    v_exp_f32 v57, v57
    v_exp_f32 v58, v58
    v_exp_f32 v59, v59
    v_exp_f32 v60, v60
    v_exp_f32 v61, v61
    v_exp_f32 v62, v62
    v_exp_f32 v63, v63
    v_smfmac_f32_32x32x32_bf16 v[80:95], v[136:139], v[48:55], v14
    buffer_load_dword v151, v160, s[28:31], s33 offen offset:4
    v_exp_f32 v64, v64
    v_exp_f32 v65, v65
    v_exp_f32 v66, v66
    v_smfmac_f32_32x32x32_bf16 v[80:95], v[144:147], v[56:63], v14
    ds_read_b128 v[128:131], v1 offset:9216
    v_exp_f32 v67, v67
    v_exp_f32 v68, v68
    v_exp_f32 v69, v69
    v_exp_f32 v70, v70
    v_exp_f32 v71, v71
    v_mfma_f32_32x32x16_bf16 v[16:31], v[124:127], v[112:115], v[16:31]
    ds_read_b64_tr_b16 v[132:133], v4 offset:11264
    ds_read_b64_tr_b16 v[134:135], v5 offset:11264
    v_exp_f32 v72, v72
    v_exp_f32 v73, v73
    v_exp_f32 v74, v74
    v_exp_f32 v75, v75
    v_mfma_f32_32x32x16_bf16 v[32:47], v[124:127], v[116:119], v[32:47]
    v_exp_f32 v76, v76
    v_exp_f32 v77, v77
    v_exp_f32 v78, v78
    v_smfmac_f32_32x32x32_bf16 v[96:111], v[136:139], v[64:71], v14
    s_waitcnt lgkmcnt(0)
    v_exp_f32 v79, v79
    v_exp_f32 v16, v16
    v_exp_f32 v17, v17
    v_exp_f32 v18, v18
    v_smfmac_f32_32x32x32_bf16 v[96:111], v[144:147], v[72:79], v14
    ds_read_b64_tr_b16 v[144:145], v6 offset:12544
    ds_read_b64_tr_b16 v[146:147], v7 offset:12544
    v_exp_f32 v19, v19
    v_exp_f32 v20, v20
    v_exp_f32 v21, v21
    v_exp_f32 v22, v22
    v_mfma_f32_32x32x4_2b_bf16 v[48:79], v[122:123], v[120:121], 0 cbsz:1 abid:1
    v_exp_f32 v23, v23
    v_exp_f32 v24, v24
    v_exp_f32 v25, v25
    v_exp_f32 v26, v26
    v_exp_f32 v27, v27
    v_exp_f32 v28, v28
    v_exp_f32 v29, v29
    v_exp_f32 v30, v30
    v_exp_f32 v31, v31
    v_smfmac_f32_32x32x32_bf16 v[80:95], v[132:135], v[16:23], v14
    s_add_u32 m0, s35, 33792
    s_nop 0
    buffer_load_dwordx4 v159, s[20:23], s33 offen lds
    v_exp_f32 v32, v32
    v_exp_f32 v33, v33
    v_exp_f32 v34, v34
    v_smfmac_f32_32x32x32_bf16 v[80:95], v[140:143], v[24:31], v14
    ds_read_b128 v[124:127], v1 offset:10240
    ds_read_b32 v122, v2 offset:14080
    v_exp_f32 v35, v35
    v_exp_f32 v36, v36
    v_exp_f32 v37, v37
    v_exp_f32 v38, v38
    v_exp_f32 v39, v39
    v_mfma_f32_32x32x16_bf16 v[48:63], v[128:131], v[112:115], v[48:63]
    ds_read_b64_tr_b16 v[136:137], v4 offset:12544
    ds_read_b64_tr_b16 v[138:139], v5 offset:12544
    v_exp_f32 v40, v40
    v_exp_f32 v41, v41
    v_exp_f32 v42, v42
    v_exp_f32 v43, v43
    v_mfma_f32_32x32x16_bf16 v[64:79], v[128:131], v[116:119], v[64:79]
    v_exp_f32 v44, v44
    v_exp_f32 v45, v45
    v_exp_f32 v46, v46
    v_smfmac_f32_32x32x32_bf16 v[96:111], v[132:135], v[32:39], v14
    s_waitcnt lgkmcnt(0)
    v_exp_f32 v47, v47
    v_exp_f32 v48, v48
    v_exp_f32 v49, v49
    v_exp_f32 v50, v50
    v_smfmac_f32_32x32x32_bf16 v[96:111], v[140:143], v[40:47], v14
    ds_read_b64_tr_b16 v[140:141], v6 offset:14080
    ds_read_b64_tr_b16 v[142:143], v7 offset:14080
    v_exp_f32 v51, v51
    v_exp_f32 v52, v52
    v_exp_f32 v53, v53
    v_exp_f32 v54, v54
    v_mfma_f32_32x32x4_2b_bf16 v[16:47], v[122:123], v[120:121], 0 cbsz:1 abid:0
    v_exp_f32 v55, v55
    v_exp_f32 v56, v56
    v_exp_f32 v57, v57
    v_exp_f32 v58, v58
    v_exp_f32 v59, v59
    v_exp_f32 v60, v60
    v_exp_f32 v61, v61
    v_exp_f32 v62, v62
    v_exp_f32 v63, v63
    v_smfmac_f32_32x32x32_bf16 v[80:95], v[136:139], v[48:55], v14
    s_add_u32 m0, s34, 32768
    s_add_u32 s33, s81, 36864
    buffer_load_dwordx4 v158, s[16:19], s33 offen lds
    v_exp_f32 v64, v64
    v_exp_f32 v65, v65
    v_exp_f32 v66, v66
    v_smfmac_f32_32x32x32_bf16 v[80:95], v[144:147], v[56:63], v14
    ds_read_b128 v[128:131], v1 offset:11264
    v_exp_f32 v67, v67
    v_exp_f32 v68, v68
    v_exp_f32 v69, v69
    v_exp_f32 v70, v70
    v_exp_f32 v71, v71
    v_mfma_f32_32x32x16_bf16 v[16:31], v[124:127], v[112:115], v[16:31]
    ds_read_b64_tr_b16 v[132:133], v4 offset:14080
    ds_read_b64_tr_b16 v[134:135], v5 offset:14080
    v_exp_f32 v72, v72
    v_exp_f32 v73, v73
    v_exp_f32 v74, v74
    v_exp_f32 v75, v75
    v_mfma_f32_32x32x16_bf16 v[32:47], v[124:127], v[116:119], v[32:47]
    v_exp_f32 v76, v76
    v_exp_f32 v77, v77
    v_exp_f32 v78, v78
    v_smfmac_f32_32x32x32_bf16 v[96:111], v[136:139], v[64:71], v14
    s_waitcnt lgkmcnt(0)
    v_exp_f32 v79, v79
    v_exp_f32 v16, v16
    v_exp_f32 v17, v17
    v_exp_f32 v18, v18
    v_smfmac_f32_32x32x32_bf16 v[96:111], v[144:147], v[72:79], v14
    ds_read_b64_tr_b16 v[144:145], v6 offset:15360
    ds_read_b64_tr_b16 v[146:147], v7 offset:15360
    v_exp_f32 v19, v19
    v_exp_f32 v20, v20
    v_exp_f32 v21, v21
    v_exp_f32 v22, v22
    v_mfma_f32_32x32x4_2b_bf16 v[48:79], v[122:123], v[120:121], 0 cbsz:1 abid:1
    v_exp_f32 v23, v23
    v_exp_f32 v24, v24
    v_exp_f32 v25, v25
    v_exp_f32 v26, v26
    v_exp_f32 v27, v27
    v_exp_f32 v28, v28
    v_exp_f32 v29, v29
    v_exp_f32 v30, v30
    v_exp_f32 v31, v31
    v_smfmac_f32_32x32x32_bf16 v[80:95], v[132:135], v[16:23], v14
    buffer_load_dword v152, v160, s[28:31], s33 offen offset:4
    v_exp_f32 v32, v32
    v_exp_f32 v33, v33
    v_exp_f32 v34, v34
    v_smfmac_f32_32x32x32_bf16 v[80:95], v[140:143], v[24:31], v14
    ds_read_b128 v[124:127], v1 offset:12288
    ds_read_b32 v122, v2 offset:16896
    v_exp_f32 v35, v35
    v_exp_f32 v36, v36
    v_exp_f32 v37, v37
    v_exp_f32 v38, v38
    v_exp_f32 v39, v39
    v_mfma_f32_32x32x16_bf16 v[48:63], v[128:131], v[112:115], v[48:63]
    ds_read_b64_tr_b16 v[136:137], v4 offset:15360
    ds_read_b64_tr_b16 v[138:139], v5 offset:15360
    v_exp_f32 v40, v40
    v_exp_f32 v41, v41
    v_exp_f32 v42, v42
    v_exp_f32 v43, v43
    v_mfma_f32_32x32x16_bf16 v[64:79], v[128:131], v[116:119], v[64:79]
    v_exp_f32 v44, v44
    v_exp_f32 v45, v45
    v_exp_f32 v46, v46
    v_smfmac_f32_32x32x32_bf16 v[96:111], v[132:135], v[32:39], v14
    s_waitcnt lgkmcnt(0)
    v_exp_f32 v47, v47
    v_exp_f32 v48, v48
    v_exp_f32 v49, v49
    v_exp_f32 v50, v50
    v_smfmac_f32_32x32x32_bf16 v[96:111], v[140:143], v[40:47], v14
    ds_read_b64_tr_b16 v[140:141], v6 offset:16896
    ds_read_b64_tr_b16 v[142:143], v7 offset:16896
    v_exp_f32 v51, v51
    v_exp_f32 v52, v52
    v_exp_f32 v53, v53
    v_exp_f32 v54, v54
    v_mfma_f32_32x32x4_2b_bf16 v[16:47], v[122:123], v[120:121], 0 cbsz:1 abid:0
    v_exp_f32 v55, v55
    v_exp_f32 v56, v56
    v_exp_f32 v57, v57
    v_exp_f32 v58, v58
    v_exp_f32 v59, v59
    v_exp_f32 v60, v60
    v_exp_f32 v61, v61
    v_exp_f32 v62, v62
    v_exp_f32 v63, v63
    v_smfmac_f32_32x32x32_bf16 v[80:95], v[136:139], v[48:55], v14
    s_add_u32 m0, s35, 45056
    s_nop 0
    buffer_load_dwordx4 v159, s[20:23], s33 offen lds
    v_exp_f32 v64, v64
    v_exp_f32 v65, v65
    v_exp_f32 v66, v66
    v_smfmac_f32_32x32x32_bf16 v[80:95], v[144:147], v[56:63], v14
    ds_read_b128 v[128:131], v1 offset:13312
    v_exp_f32 v67, v67
    v_exp_f32 v68, v68
    v_exp_f32 v69, v69
    v_exp_f32 v70, v70
    v_exp_f32 v71, v71
    v_mfma_f32_32x32x16_bf16 v[16:31], v[124:127], v[112:115], v[16:31]
    ds_read_b64_tr_b16 v[132:133], v4 offset:16896
    ds_read_b64_tr_b16 v[134:135], v5 offset:16896
    v_exp_f32 v72, v72
    v_exp_f32 v73, v73
    v_exp_f32 v74, v74
    v_exp_f32 v75, v75
    v_mfma_f32_32x32x16_bf16 v[32:47], v[124:127], v[116:119], v[32:47]
    v_exp_f32 v76, v76
    v_exp_f32 v77, v77
    v_exp_f32 v78, v78
    v_smfmac_f32_32x32x32_bf16 v[96:111], v[136:139], v[64:71], v14
    s_waitcnt lgkmcnt(0)
    v_exp_f32 v79, v79
    v_exp_f32 v16, v16
    v_exp_f32 v17, v17
    v_exp_f32 v18, v18
    v_smfmac_f32_32x32x32_bf16 v[96:111], v[144:147], v[72:79], v14
    s_setprio 2
    ds_read_b64_tr_b16 v[144:145], v6 offset:18176
    ds_read_b64_tr_b16 v[146:147], v7 offset:18176
    v_exp_f32 v19, v19
    v_exp_f32 v20, v20
    v_exp_f32 v21, v21
    v_exp_f32 v22, v22
    v_mfma_f32_32x32x4_2b_bf16 v[48:79], v[122:123], v[120:121], 0 cbsz:1 abid:1
    v_exp_f32 v23, v23
    v_exp_f32 v24, v24
    v_exp_f32 v25, v25
    v_exp_f32 v26, v26
    v_exp_f32 v27, v27
    v_exp_f32 v28, v28
    v_exp_f32 v29, v29
    v_exp_f32 v30, v30
    v_exp_f32 v31, v31
    v_smfmac_f32_32x32x32_bf16 v[80:95], v[132:135], v[16:23], v14
    s_add_u32 m0, s34, 40960
    s_add_u32 s33, s81, 46080
    buffer_load_dwordx4 v158, s[16:19], s33 offen lds
    v_exp_f32 v32, v32
    v_exp_f32 v33, v33
    v_exp_f32 v34, v34
    v_smfmac_f32_32x32x32_bf16 v[80:95], v[140:143], v[24:31], v14
    ds_read_b128 v[124:127], v1 offset:14336
    ds_read_b32 v122, v2 offset:19712
    v_exp_f32 v35, v35
    v_exp_f32 v36, v36
    v_exp_f32 v37, v37
    v_exp_f32 v38, v38
    v_exp_f32 v39, v39
    v_mfma_f32_32x32x16_bf16 v[48:63], v[128:131], v[112:115], v[48:63]
    ds_read_b64_tr_b16 v[136:137], v4 offset:18176
    ds_read_b64_tr_b16 v[138:139], v5 offset:18176
    v_exp_f32 v40, v40
    v_exp_f32 v41, v41
    v_exp_f32 v42, v42
    v_exp_f32 v43, v43
    v_mfma_f32_32x32x16_bf16 v[64:79], v[128:131], v[116:119], v[64:79]
    s_waitcnt vmcnt(7)
    ds_write_b32 v12, v150 offset:22528
    v_exp_f32 v44, v44
    v_exp_f32 v45, v45
    v_exp_f32 v46, v46
    v_smfmac_f32_32x32x32_bf16 v[96:111], v[132:135], v[32:39], v14
    s_waitcnt lgkmcnt(1)
    v_exp_f32 v47, v47
    v_exp_f32 v48, v48
    v_exp_f32 v49, v49
    v_exp_f32 v50, v50
    v_smfmac_f32_32x32x32_bf16 v[96:111], v[140:143], v[40:47], v14
    ds_read_b64_tr_b16 v[140:141], v6 offset:19712
    ds_read_b64_tr_b16 v[142:143], v7 offset:19712
    v_exp_f32 v51, v51
    v_exp_f32 v52, v52
    v_exp_f32 v53, v53
    v_exp_f32 v54, v54
    v_mfma_f32_32x32x4_2b_bf16 v[16:47], v[122:123], v[120:121], 0 cbsz:1 abid:0
    v_exp_f32 v55, v55
    v_exp_f32 v56, v56
    v_exp_f32 v57, v57
    v_exp_f32 v58, v58
    v_exp_f32 v59, v59
    v_exp_f32 v60, v60
    v_exp_f32 v61, v61
    v_exp_f32 v62, v62
    v_exp_f32 v63, v63
    v_smfmac_f32_32x32x32_bf16 v[80:95], v[136:139], v[48:55], v14
    buffer_load_dword v153, v160, s[28:31], s33 offen offset:4
    v_exp_f32 v64, v64
    v_exp_f32 v65, v65
    v_exp_f32 v66, v66
    v_smfmac_f32_32x32x32_bf16 v[80:95], v[144:147], v[56:63], v14
    s_setprio 1
    ds_read_b128 v[128:131], v1 offset:15360
    v_exp_f32 v67, v67
    v_exp_f32 v68, v68
    v_exp_f32 v69, v69
    v_exp_f32 v70, v70
    v_exp_f32 v71, v71
    v_mfma_f32_32x32x16_bf16 v[16:31], v[124:127], v[112:115], v[16:31]
    ds_read_b64_tr_b16 v[132:133], v4 offset:19712
    ds_read_b64_tr_b16 v[134:135], v5 offset:19712
    v_exp_f32 v72, v72
    v_exp_f32 v73, v73
    v_exp_f32 v74, v74
    v_exp_f32 v75, v75
    v_mfma_f32_32x32x16_bf16 v[32:47], v[124:127], v[116:119], v[32:47]
    s_waitcnt vmcnt(5)
    ds_write_b32 v12, v151 offset:33792
    v_exp_f32 v76, v76
    v_exp_f32 v77, v77
    v_exp_f32 v78, v78
    v_smfmac_f32_32x32x32_bf16 v[96:111], v[136:139], v[64:71], v14
    s_waitcnt lgkmcnt(0)
    v_exp_f32 v79, v79
    v_exp_f32 v16, v16
    v_exp_f32 v17, v17
    v_exp_f32 v18, v18
    v_smfmac_f32_32x32x32_bf16 v[96:111], v[144:147], v[72:79], v14
    s_setprio 0
    ds_read_b64_tr_b16 v[144:145], v6 offset:20992
    ds_read_b64_tr_b16 v[146:147], v7 offset:20992
    v_exp_f32 v19, v19
    v_exp_f32 v20, v20
    v_exp_f32 v21, v21
    v_exp_f32 v22, v22
    v_mfma_f32_32x32x4_2b_bf16 v[48:79], v[122:123], v[120:121], 0 cbsz:1 abid:1
    v_exp_f32 v23, v23
    v_exp_f32 v24, v24
    v_exp_f32 v25, v25
    v_exp_f32 v26, v26
    v_exp_f32 v27, v27
    v_exp_f32 v28, v28
    v_exp_f32 v29, v29
    v_exp_f32 v30, v30
    v_exp_f32 v31, v31
    v_smfmac_f32_32x32x32_bf16 v[80:95], v[132:135], v[16:23], v14
    s_add_u32 m0, s35, 56320
    s_nop 0
    buffer_load_dwordx4 v159, s[20:23], s33 offen lds
    v_exp_f32 v32, v32
    v_exp_f32 v33, v33
    v_exp_f32 v34, v34
    v_smfmac_f32_32x32x32_bf16 v[80:95], v[140:143], v[24:31], v14
    s_barrier
    s_setprio 3
    ds_read_b128 v[124:127], v1 offset:16384
    ds_read_b32 v122, v2 offset:22528
    v_exp_f32 v35, v35
    v_exp_f32 v36, v36
    v_exp_f32 v37, v37
    v_exp_f32 v38, v38
    v_exp_f32 v39, v39
    v_mfma_f32_32x32x16_bf16 v[48:63], v[128:131], v[112:115], v[48:63]
    ds_read_b64_tr_b16 v[136:137], v4 offset:20992
    ds_read_b64_tr_b16 v[138:139], v5 offset:20992
    v_exp_f32 v40, v40
    v_exp_f32 v41, v41
    v_exp_f32 v42, v42
    v_exp_f32 v43, v43
    v_mfma_f32_32x32x16_bf16 v[64:79], v[128:131], v[116:119], v[64:79]
    v_exp_f32 v44, v44
    v_exp_f32 v45, v45
    v_exp_f32 v46, v46
    v_smfmac_f32_32x32x32_bf16 v[96:111], v[132:135], v[32:39], v14
    s_waitcnt lgkmcnt(0)
    v_exp_f32 v47, v47
    v_exp_f32 v48, v48
    v_exp_f32 v49, v49
    v_exp_f32 v50, v50
    v_smfmac_f32_32x32x32_bf16 v[96:111], v[140:143], v[40:47], v14
    ds_read_b64_tr_b16 v[140:141], v6 offset:22528
    ds_read_b64_tr_b16 v[142:143], v7 offset:22528
    v_exp_f32 v51, v51
    v_exp_f32 v52, v52
    v_exp_f32 v53, v53
    v_exp_f32 v54, v54
    v_mfma_f32_32x32x4_2b_bf16 v[16:47], v[122:123], v[120:121], 0 cbsz:1 abid:0
    v_exp_f32 v55, v55
    v_exp_f32 v56, v56
    v_exp_f32 v57, v57
    v_exp_f32 v58, v58
    v_exp_f32 v59, v59
    v_exp_f32 v60, v60
    v_exp_f32 v61, v61
    v_exp_f32 v62, v62
    v_exp_f32 v63, v63
    v_smfmac_f32_32x32x32_bf16 v[80:95], v[136:139], v[48:55], v14
    s_add_u32 m0, s34, 49152
    s_add_u32 s33, s81, 55296
    buffer_load_dwordx4 v158, s[16:19], s33 offen lds
    v_exp_f32 v64, v64
    v_exp_f32 v65, v65
    v_exp_f32 v66, v66
    v_smfmac_f32_32x32x32_bf16 v[80:95], v[144:147], v[56:63], v14
    ds_read_b128 v[128:131], v1 offset:17408
    v_exp_f32 v67, v67
    v_exp_f32 v68, v68
    v_exp_f32 v69, v69
    v_exp_f32 v70, v70
    v_exp_f32 v71, v71
    v_mfma_f32_32x32x16_bf16 v[16:31], v[124:127], v[112:115], v[16:31]
    ds_read_b64_tr_b16 v[132:133], v4 offset:22528
    ds_read_b64_tr_b16 v[134:135], v5 offset:22528
    v_exp_f32 v72, v72
    v_exp_f32 v73, v73
    v_exp_f32 v74, v74
    v_exp_f32 v75, v75
    v_mfma_f32_32x32x16_bf16 v[32:47], v[124:127], v[116:119], v[32:47]
    v_exp_f32 v76, v76
    v_exp_f32 v77, v77
    v_exp_f32 v78, v78
    v_smfmac_f32_32x32x32_bf16 v[96:111], v[136:139], v[64:71], v14
    s_waitcnt lgkmcnt(0)
    v_exp_f32 v79, v79
    v_exp_f32 v16, v16
    v_exp_f32 v17, v17
    v_exp_f32 v18, v18
    v_smfmac_f32_32x32x32_bf16 v[96:111], v[144:147], v[72:79], v14
    ds_read_b64_tr_b16 v[144:145], v6 offset:23808
    ds_read_b64_tr_b16 v[146:147], v7 offset:23808
    v_exp_f32 v19, v19
    v_exp_f32 v20, v20
    v_exp_f32 v21, v21
    v_exp_f32 v22, v22
    v_mfma_f32_32x32x4_2b_bf16 v[48:79], v[122:123], v[120:121], 0 cbsz:1 abid:1
    v_exp_f32 v23, v23
    v_exp_f32 v24, v24
    v_exp_f32 v25, v25
    v_exp_f32 v26, v26
    v_exp_f32 v27, v27
    v_exp_f32 v28, v28
    v_exp_f32 v29, v29
    v_exp_f32 v30, v30
    v_exp_f32 v31, v31
    v_smfmac_f32_32x32x32_bf16 v[80:95], v[132:135], v[16:23], v14
    buffer_load_dword v154, v160, s[28:31], s33 offen offset:4
    v_exp_f32 v32, v32
    v_exp_f32 v33, v33
    v_exp_f32 v34, v34
    v_smfmac_f32_32x32x32_bf16 v[80:95], v[140:143], v[24:31], v14
    ds_read_b128 v[124:127], v1 offset:18432
    ds_read_b32 v122, v2 offset:25344
    v_exp_f32 v35, v35
    v_exp_f32 v36, v36
    v_exp_f32 v37, v37
    v_exp_f32 v38, v38
    v_exp_f32 v39, v39
    v_mfma_f32_32x32x16_bf16 v[48:63], v[128:131], v[112:115], v[48:63]
    ds_read_b64_tr_b16 v[136:137], v4 offset:23808
    ds_read_b64_tr_b16 v[138:139], v5 offset:23808
    v_exp_f32 v40, v40
    v_exp_f32 v41, v41
    v_exp_f32 v42, v42
    v_exp_f32 v43, v43
    v_mfma_f32_32x32x16_bf16 v[64:79], v[128:131], v[116:119], v[64:79]
    v_exp_f32 v44, v44
    v_exp_f32 v45, v45
    v_exp_f32 v46, v46
    v_smfmac_f32_32x32x32_bf16 v[96:111], v[132:135], v[32:39], v14
    s_waitcnt lgkmcnt(0)
    v_exp_f32 v47, v47
    v_exp_f32 v48, v48
    v_exp_f32 v49, v49
    v_exp_f32 v50, v50
    v_smfmac_f32_32x32x32_bf16 v[96:111], v[140:143], v[40:47], v14
    ds_read_b64_tr_b16 v[140:141], v6 offset:25344
    ds_read_b64_tr_b16 v[142:143], v7 offset:25344
    v_exp_f32 v51, v51
    v_exp_f32 v52, v52
    v_exp_f32 v53, v53
    v_exp_f32 v54, v54
    v_mfma_f32_32x32x4_2b_bf16 v[16:47], v[122:123], v[120:121], 0 cbsz:1 abid:0
    v_exp_f32 v55, v55
    v_exp_f32 v56, v56
    v_exp_f32 v57, v57
    v_exp_f32 v58, v58
    v_exp_f32 v59, v59
    v_exp_f32 v60, v60
    v_exp_f32 v61, v61
    v_exp_f32 v62, v62
    v_exp_f32 v63, v63
    v_smfmac_f32_32x32x32_bf16 v[80:95], v[136:139], v[48:55], v14
    s_add_u32 m0, s35, 67584
    s_nop 0
    buffer_load_dwordx4 v159, s[20:23], s33 offen lds
    v_exp_f32 v64, v64
    v_exp_f32 v65, v65
    v_exp_f32 v66, v66
    v_smfmac_f32_32x32x32_bf16 v[80:95], v[144:147], v[56:63], v14
    ds_read_b128 v[128:131], v1 offset:19456
    v_exp_f32 v67, v67
    v_exp_f32 v68, v68
    v_exp_f32 v69, v69
    v_exp_f32 v70, v70
    v_exp_f32 v71, v71
    v_mfma_f32_32x32x16_bf16 v[16:31], v[124:127], v[112:115], v[16:31]
    ds_read_b64_tr_b16 v[132:133], v4 offset:25344
    ds_read_b64_tr_b16 v[134:135], v5 offset:25344
    v_exp_f32 v72, v72
    v_exp_f32 v73, v73
    v_exp_f32 v74, v74
    v_exp_f32 v75, v75
    v_mfma_f32_32x32x16_bf16 v[32:47], v[124:127], v[116:119], v[32:47]
    v_exp_f32 v76, v76
    v_exp_f32 v77, v77
    v_exp_f32 v78, v78
    v_smfmac_f32_32x32x32_bf16 v[96:111], v[136:139], v[64:71], v14
    s_waitcnt lgkmcnt(0)
    v_exp_f32 v79, v79
    v_exp_f32 v16, v16
    v_exp_f32 v17, v17
    v_exp_f32 v18, v18
    v_smfmac_f32_32x32x32_bf16 v[96:111], v[144:147], v[72:79], v14
    ds_read_b64_tr_b16 v[144:145], v6 offset:26624
    ds_read_b64_tr_b16 v[146:147], v7 offset:26624
    v_exp_f32 v19, v19
    v_exp_f32 v20, v20
    v_exp_f32 v21, v21
    v_exp_f32 v22, v22
    v_mfma_f32_32x32x4_2b_bf16 v[48:79], v[122:123], v[120:121], 0 cbsz:1 abid:1
    v_exp_f32 v23, v23
    v_exp_f32 v24, v24
    v_exp_f32 v25, v25
    v_exp_f32 v26, v26
    v_exp_f32 v27, v27
    v_exp_f32 v28, v28
    v_exp_f32 v29, v29
    v_exp_f32 v30, v30
    v_exp_f32 v31, v31
    v_smfmac_f32_32x32x32_bf16 v[80:95], v[132:135], v[16:23], v14
    s_add_u32 m0, s34, 57344
    s_add_u32 s33, s81, 64512
    buffer_load_dwordx4 v158, s[16:19], s33 offen lds
    v_exp_f32 v32, v32
    v_exp_f32 v33, v33
    v_exp_f32 v34, v34
    v_smfmac_f32_32x32x32_bf16 v[80:95], v[140:143], v[24:31], v14
    ds_read_b128 v[124:127], v1 offset:20480
    ds_read_b32 v122, v2 offset:28160
    v_exp_f32 v35, v35
    v_exp_f32 v36, v36
    v_exp_f32 v37, v37
    v_exp_f32 v38, v38
    v_exp_f32 v39, v39
    v_mfma_f32_32x32x16_bf16 v[48:63], v[128:131], v[112:115], v[48:63]
    ds_read_b64_tr_b16 v[136:137], v4 offset:26624
    ds_read_b64_tr_b16 v[138:139], v5 offset:26624
    v_exp_f32 v40, v40
    v_exp_f32 v41, v41
    v_exp_f32 v42, v42
    v_exp_f32 v43, v43
    v_mfma_f32_32x32x16_bf16 v[64:79], v[128:131], v[116:119], v[64:79]
    v_exp_f32 v44, v44
    v_exp_f32 v45, v45
    v_exp_f32 v46, v46
    v_smfmac_f32_32x32x32_bf16 v[96:111], v[132:135], v[32:39], v14
    s_waitcnt lgkmcnt(0)
    v_exp_f32 v47, v47
    v_exp_f32 v48, v48
    v_exp_f32 v49, v49
    v_exp_f32 v50, v50
    v_smfmac_f32_32x32x32_bf16 v[96:111], v[140:143], v[40:47], v14
    ds_read_b64_tr_b16 v[140:141], v6 offset:28160
    ds_read_b64_tr_b16 v[142:143], v7 offset:28160
    v_exp_f32 v51, v51
    v_exp_f32 v52, v52
    v_exp_f32 v53, v53
    v_exp_f32 v54, v54
    v_mfma_f32_32x32x4_2b_bf16 v[16:47], v[122:123], v[120:121], 0 cbsz:1 abid:0
    v_exp_f32 v55, v55
    v_exp_f32 v56, v56
    v_exp_f32 v57, v57
    v_exp_f32 v58, v58
    v_exp_f32 v59, v59
    v_exp_f32 v60, v60
    v_exp_f32 v61, v61
    v_exp_f32 v62, v62
    v_exp_f32 v63, v63
    v_smfmac_f32_32x32x32_bf16 v[80:95], v[136:139], v[48:55], v14
    buffer_load_dword v155, v160, s[28:31], s33 offen offset:4
    v_exp_f32 v64, v64
    v_exp_f32 v65, v65
    v_exp_f32 v66, v66
    v_smfmac_f32_32x32x32_bf16 v[80:95], v[144:147], v[56:63], v14
    ds_read_b128 v[128:131], v1 offset:21504
    v_exp_f32 v67, v67
    v_exp_f32 v68, v68
    v_exp_f32 v69, v69
    v_exp_f32 v70, v70
    v_exp_f32 v71, v71
    v_mfma_f32_32x32x16_bf16 v[16:31], v[124:127], v[112:115], v[16:31]
    ds_read_b64_tr_b16 v[132:133], v4 offset:28160
    ds_read_b64_tr_b16 v[134:135], v5 offset:28160
    v_exp_f32 v72, v72
    v_exp_f32 v73, v73
    v_exp_f32 v74, v74
    v_exp_f32 v75, v75
    v_mfma_f32_32x32x16_bf16 v[32:47], v[124:127], v[116:119], v[32:47]
    v_exp_f32 v76, v76
    v_exp_f32 v77, v77
    v_exp_f32 v78, v78
    v_smfmac_f32_32x32x32_bf16 v[96:111], v[136:139], v[64:71], v14
    s_waitcnt lgkmcnt(0)
    v_exp_f32 v79, v79
    v_exp_f32 v16, v16
    v_exp_f32 v17, v17
    v_exp_f32 v18, v18
    v_smfmac_f32_32x32x32_bf16 v[96:111], v[144:147], v[72:79], v14
    ds_read_b64_tr_b16 v[144:145], v6 offset:29440
    ds_read_b64_tr_b16 v[146:147], v7 offset:29440
    v_exp_f32 v19, v19
    v_exp_f32 v20, v20
    v_exp_f32 v21, v21
    v_exp_f32 v22, v22
    v_mfma_f32_32x32x4_2b_bf16 v[48:79], v[122:123], v[120:121], 0 cbsz:1 abid:1
    v_exp_f32 v23, v23
    v_exp_f32 v24, v24
    v_exp_f32 v25, v25
    v_exp_f32 v26, v26
    v_exp_f32 v27, v27
    v_exp_f32 v28, v28
    v_exp_f32 v29, v29
    v_exp_f32 v30, v30
    v_exp_f32 v31, v31
    v_smfmac_f32_32x32x32_bf16 v[80:95], v[132:135], v[16:23], v14
    s_add_u32 m0, s35, 78848
    s_nop 0
    buffer_load_dwordx4 v159, s[20:23], s33 offen lds
    v_exp_f32 v32, v32
    v_exp_f32 v33, v33
    v_exp_f32 v34, v34
    v_smfmac_f32_32x32x32_bf16 v[80:95], v[140:143], v[24:31], v14
    ds_read_b128 v[124:127], v1 offset:22528
    ds_read_b32 v122, v2 offset:30976
    v_exp_f32 v35, v35
    v_exp_f32 v36, v36
    v_exp_f32 v37, v37
    v_exp_f32 v38, v38
    v_exp_f32 v39, v39
    v_mfma_f32_32x32x16_bf16 v[48:63], v[128:131], v[112:115], v[48:63]
    ds_read_b64_tr_b16 v[136:137], v4 offset:29440
    ds_read_b64_tr_b16 v[138:139], v5 offset:29440
    v_exp_f32 v40, v40
    v_exp_f32 v41, v41
    v_exp_f32 v42, v42
    v_exp_f32 v43, v43
    v_mfma_f32_32x32x16_bf16 v[64:79], v[128:131], v[116:119], v[64:79]
    v_exp_f32 v44, v44
    v_exp_f32 v45, v45
    v_exp_f32 v46, v46
    v_smfmac_f32_32x32x32_bf16 v[96:111], v[132:135], v[32:39], v14
    s_waitcnt lgkmcnt(0)
    v_exp_f32 v47, v47
    v_exp_f32 v48, v48
    v_exp_f32 v49, v49
    v_exp_f32 v50, v50
    v_smfmac_f32_32x32x32_bf16 v[96:111], v[140:143], v[40:47], v14
    ds_read_b64_tr_b16 v[140:141], v6 offset:30976
    ds_read_b64_tr_b16 v[142:143], v7 offset:30976
    v_exp_f32 v51, v51
    v_exp_f32 v52, v52
    v_exp_f32 v53, v53
    v_exp_f32 v54, v54
    v_mfma_f32_32x32x4_2b_bf16 v[16:47], v[122:123], v[120:121], 0 cbsz:1 abid:0
    v_exp_f32 v55, v55
    v_exp_f32 v56, v56
    v_exp_f32 v57, v57
    v_exp_f32 v58, v58
    v_exp_f32 v59, v59
    v_exp_f32 v60, v60
    v_exp_f32 v61, v61
    v_exp_f32 v62, v62
    v_exp_f32 v63, v63
    v_smfmac_f32_32x32x32_bf16 v[80:95], v[136:139], v[48:55], v14
    v_exp_f32 v64, v64
    v_exp_f32 v65, v65
    v_exp_f32 v66, v66
    v_smfmac_f32_32x32x32_bf16 v[80:95], v[144:147], v[56:63], v14
    ds_read_b128 v[128:131], v1 offset:23552
    v_exp_f32 v67, v67
    v_exp_f32 v68, v68
    v_exp_f32 v69, v69
    v_exp_f32 v70, v70
    v_exp_f32 v71, v71
    v_mfma_f32_32x32x16_bf16 v[16:31], v[124:127], v[112:115], v[16:31]
    ds_read_b64_tr_b16 v[132:133], v4 offset:30976
    ds_read_b64_tr_b16 v[134:135], v5 offset:30976
    v_exp_f32 v72, v72
    v_exp_f32 v73, v73
    v_exp_f32 v74, v74
    v_exp_f32 v75, v75
    v_mfma_f32_32x32x16_bf16 v[32:47], v[124:127], v[116:119], v[32:47]
    v_exp_f32 v76, v76
    v_exp_f32 v77, v77
    v_exp_f32 v78, v78
    v_smfmac_f32_32x32x32_bf16 v[96:111], v[136:139], v[64:71], v14
    s_waitcnt lgkmcnt(0)
    v_exp_f32 v79, v79
    v_exp_f32 v16, v16
    v_exp_f32 v17, v17
    v_exp_f32 v18, v18
    v_smfmac_f32_32x32x32_bf16 v[96:111], v[144:147], v[72:79], v14
    ds_read_b64_tr_b16 v[144:145], v6 offset:32256
    ds_read_b64_tr_b16 v[146:147], v7 offset:32256
    v_exp_f32 v19, v19
    v_exp_f32 v20, v20
    v_exp_f32 v21, v21
    v_exp_f32 v22, v22
    v_mfma_f32_32x32x4_2b_bf16 v[48:79], v[122:123], v[120:121], 0 cbsz:1 abid:1
    v_exp_f32 v23, v23
    v_exp_f32 v24, v24
    v_exp_f32 v25, v25
    v_exp_f32 v26, v26
    v_exp_f32 v27, v27
    v_exp_f32 v28, v28
    v_exp_f32 v29, v29
    v_exp_f32 v30, v30
    v_exp_f32 v31, v31
    v_smfmac_f32_32x32x32_bf16 v[80:95], v[132:135], v[16:23], v14
    v_exp_f32 v32, v32
    v_exp_f32 v33, v33
    v_exp_f32 v34, v34
    v_smfmac_f32_32x32x32_bf16 v[80:95], v[140:143], v[24:31], v14
    ds_read_b128 v[124:127], v1 offset:24576
    ds_read_b32 v122, v2 offset:33792
    v_exp_f32 v35, v35
    v_exp_f32 v36, v36
    v_exp_f32 v37, v37
    v_exp_f32 v38, v38
    v_exp_f32 v39, v39
    v_mfma_f32_32x32x16_bf16 v[48:63], v[128:131], v[112:115], v[48:63]
    ds_read_b64_tr_b16 v[136:137], v4 offset:32256
    ds_read_b64_tr_b16 v[138:139], v5 offset:32256
    v_exp_f32 v40, v40
    v_exp_f32 v41, v41
    v_exp_f32 v42, v42
    v_exp_f32 v43, v43
    v_mfma_f32_32x32x16_bf16 v[64:79], v[128:131], v[116:119], v[64:79]
    v_exp_f32 v44, v44
    v_exp_f32 v45, v45
    v_exp_f32 v46, v46
    v_smfmac_f32_32x32x32_bf16 v[96:111], v[132:135], v[32:39], v14
    s_waitcnt lgkmcnt(0)
    v_exp_f32 v47, v47
    v_exp_f32 v48, v48
    v_exp_f32 v49, v49
    v_exp_f32 v50, v50
    v_smfmac_f32_32x32x32_bf16 v[96:111], v[140:143], v[40:47], v14
    ds_read_b64_tr_b16 v[140:141], v6 offset:33792
    ds_read_b64_tr_b16 v[142:143], v7 offset:33792
    v_exp_f32 v51, v51
    v_exp_f32 v52, v52
    v_exp_f32 v53, v53
    v_exp_f32 v54, v54
    v_mfma_f32_32x32x4_2b_bf16 v[16:47], v[122:123], v[120:121], 0 cbsz:1 abid:0
L_t2:
    s_cbranch_execz L_ret
    v_exp_f32 v55, v55
    v_exp_f32 v56, v56
    v_exp_f32 v57, v57
    v_exp_f32 v58, v58
    v_exp_f32 v59, v59
    v_exp_f32 v60, v60
    v_exp_f32 v61, v61
    v_exp_f32 v62, v62
    v_exp_f32 v63, v63
    v_smfmac_f32_32x32x32_bf16 v[80:95], v[136:139], v[48:55], v14
    v_exp_f32 v64, v64
    v_exp_f32 v65, v65
    v_exp_f32 v66, v66
    v_smfmac_f32_32x32x32_bf16 v[80:95], v[144:147], v[56:63], v14
    ds_read_b128 v[128:131], v1 offset:25600
    v_exp_f32 v67, v67
    v_exp_f32 v68, v68
    v_exp_f32 v69, v69
    v_exp_f32 v70, v70
    v_exp_f32 v71, v71
    v_mfma_f32_32x32x16_bf16 v[16:31], v[124:127], v[112:115], v[16:31]
    ds_read_b64_tr_b16 v[132:133], v4 offset:33792
    ds_read_b64_tr_b16 v[134:135], v5 offset:33792
    v_exp_f32 v72, v72
    v_exp_f32 v73, v73
    v_exp_f32 v74, v74
    v_exp_f32 v75, v75
    v_mfma_f32_32x32x16_bf16 v[32:47], v[124:127], v[116:119], v[32:47]
    v_exp_f32 v76, v76
    v_exp_f32 v77, v77
    v_exp_f32 v78, v78
    v_smfmac_f32_32x32x32_bf16 v[96:111], v[136:139], v[64:71], v14
    s_waitcnt lgkmcnt(0)
    v_exp_f32 v79, v79
    v_exp_f32 v16, v16
    v_exp_f32 v17, v17
    v_exp_f32 v18, v18
    v_smfmac_f32_32x32x32_bf16 v[96:111], v[144:147], v[72:79], v14
    ds_read_b64_tr_b16 v[144:145], v6 offset:35072
    ds_read_b64_tr_b16 v[146:147], v7 offset:35072
    v_exp_f32 v19, v19
    v_exp_f32 v20, v20
    v_exp_f32 v21, v21
    v_exp_f32 v22, v22
    v_mfma_f32_32x32x4_2b_bf16 v[48:79], v[122:123], v[120:121], 0 cbsz:1 abid:1
    v_exp_f32 v23, v23
    v_exp_f32 v24, v24
    v_exp_f32 v25, v25
    v_exp_f32 v26, v26
    v_exp_f32 v27, v27
    v_exp_f32 v28, v28
    v_exp_f32 v29, v29
    v_exp_f32 v30, v30
    v_exp_f32 v31, v31
    v_smfmac_f32_32x32x32_bf16 v[80:95], v[132:135], v[16:23], v14
    v_exp_f32 v32, v32
    v_exp_f32 v33, v33
    v_exp_f32 v34, v34
    v_smfmac_f32_32x32x32_bf16 v[80:95], v[140:143], v[24:31], v14
    ds_read_b128 v[124:127], v1 offset:26624
    ds_read_b32 v122, v2 offset:36608
    v_exp_f32 v35, v35
    v_exp_f32 v36, v36
    v_exp_f32 v37, v37
    v_exp_f32 v38, v38
    v_exp_f32 v39, v39
    v_mfma_f32_32x32x16_bf16 v[48:63], v[128:131], v[112:115], v[48:63]
    ds_read_b64_tr_b16 v[136:137], v4 offset:35072
    ds_read_b64_tr_b16 v[138:139], v5 offset:35072
    v_exp_f32 v40, v40
    v_exp_f32 v41, v41
    v_exp_f32 v42, v42
    v_exp_f32 v43, v43
    v_mfma_f32_32x32x16_bf16 v[64:79], v[128:131], v[116:119], v[64:79]
    s_waitcnt vmcnt(9)
    ds_write_b32 v13, v152 offset:0
    v_exp_f32 v44, v44
    v_exp_f32 v45, v45
    v_exp_f32 v46, v46
    v_smfmac_f32_32x32x32_bf16 v[96:111], v[132:135], v[32:39], v14
    s_waitcnt lgkmcnt(1)
    v_exp_f32 v47, v47
    v_exp_f32 v48, v48
    v_exp_f32 v49, v49
    v_exp_f32 v50, v50
    v_smfmac_f32_32x32x32_bf16 v[96:111], v[140:143], v[40:47], v14
    ds_read_b64_tr_b16 v[140:141], v6 offset:36608
    ds_read_b64_tr_b16 v[142:143], v7 offset:36608
    v_exp_f32 v51, v51
    v_exp_f32 v52, v52
    v_exp_f32 v53, v53
    v_exp_f32 v54, v54
    v_mfma_f32_32x32x4_2b_bf16 v[16:47], v[122:123], v[120:121], 0 cbsz:1 abid:0
    v_exp_f32 v55, v55
    v_exp_f32 v56, v56
    v_exp_f32 v57, v57
    v_exp_f32 v58, v58
    v_exp_f32 v59, v59
    v_exp_f32 v60, v60
    v_exp_f32 v61, v61
    v_exp_f32 v62, v62
    v_exp_f32 v63, v63
    v_smfmac_f32_32x32x32_bf16 v[80:95], v[136:139], v[48:55], v14
    v_exp_f32 v64, v64
    v_exp_f32 v65, v65
    v_exp_f32 v66, v66
    v_smfmac_f32_32x32x32_bf16 v[80:95], v[144:147], v[56:63], v14
    ds_read_b128 v[128:131], v1 offset:27648
    v_exp_f32 v67, v67
    v_exp_f32 v68, v68
    v_exp_f32 v69, v69
    v_exp_f32 v70, v70
    v_exp_f32 v71, v71
    v_mfma_f32_32x32x16_bf16 v[16:31], v[124:127], v[112:115], v[16:31]
    ds_read_b64_tr_b16 v[132:133], v4 offset:36608
    ds_read_b64_tr_b16 v[134:135], v5 offset:36608
    v_exp_f32 v72, v72
    v_exp_f32 v73, v73
    v_exp_f32 v74, v74
    v_exp_f32 v75, v75
    v_mfma_f32_32x32x16_bf16 v[32:47], v[124:127], v[116:119], v[32:47]
    s_waitcnt vmcnt(6)
    ds_write_b32 v13, v153 offset:11264
    v_exp_f32 v76, v76
    v_exp_f32 v77, v77
    v_exp_f32 v78, v78
    v_smfmac_f32_32x32x32_bf16 v[96:111], v[136:139], v[64:71], v14
    s_waitcnt lgkmcnt(1)
    v_exp_f32 v79, v79
    v_exp_f32 v16, v16
    v_exp_f32 v17, v17
    v_exp_f32 v18, v18
    v_smfmac_f32_32x32x32_bf16 v[96:111], v[144:147], v[72:79], v14
    s_setprio 2
    ds_read_b64_tr_b16 v[144:145], v6 offset:37888
    ds_read_b64_tr_b16 v[146:147], v7 offset:37888
    v_exp_f32 v19, v19
    v_exp_f32 v20, v20
    v_exp_f32 v21, v21
    v_exp_f32 v22, v22
    v_mfma_f32_32x32x4_2b_bf16 v[48:79], v[122:123], v[120:121], 0 cbsz:1 abid:1
    v_exp_f32 v23, v23
    v_exp_f32 v24, v24
    v_exp_f32 v25, v25
    v_exp_f32 v26, v26
    v_exp_f32 v27, v27
    v_exp_f32 v28, v28
    v_exp_f32 v29, v29
    v_exp_f32 v30, v30
    v_exp_f32 v31, v31
    v_smfmac_f32_32x32x32_bf16 v[80:95], v[132:135], v[16:23], v14
    v_exp_f32 v32, v32
    v_exp_f32 v33, v33
    v_exp_f32 v34, v34
    v_smfmac_f32_32x32x32_bf16 v[80:95], v[140:143], v[24:31], v14
    ds_read_b128 v[124:127], v1 offset:28672
    ds_read_b32 v122, v2 offset:39424
    v_exp_f32 v35, v35
    v_exp_f32 v36, v36
    v_exp_f32 v37, v37
    v_exp_f32 v38, v38
    v_exp_f32 v39, v39
    v_mfma_f32_32x32x16_bf16 v[48:63], v[128:131], v[112:115], v[48:63]
    ds_read_b64_tr_b16 v[136:137], v4 offset:37888
    ds_read_b64_tr_b16 v[138:139], v5 offset:37888
    v_exp_f32 v40, v40
    v_exp_f32 v41, v41
    v_exp_f32 v42, v42
    v_exp_f32 v43, v43
    v_mfma_f32_32x32x16_bf16 v[64:79], v[128:131], v[116:119], v[64:79]
    s_waitcnt vmcnt(3)
    ds_write_b32 v13, v154 offset:22528
    v_exp_f32 v44, v44
    v_exp_f32 v45, v45
    v_exp_f32 v46, v46
    v_smfmac_f32_32x32x32_bf16 v[96:111], v[132:135], v[32:39], v14
    s_waitcnt lgkmcnt(1)
    v_exp_f32 v47, v47
    v_exp_f32 v48, v48
    v_exp_f32 v49, v49
    v_exp_f32 v50, v50
    v_smfmac_f32_32x32x32_bf16 v[96:111], v[140:143], v[40:47], v14
    ds_read_b64_tr_b16 v[140:141], v6 offset:39424
    ds_read_b64_tr_b16 v[142:143], v7 offset:39424
    v_exp_f32 v51, v51
    v_exp_f32 v52, v52
    v_exp_f32 v53, v53
    v_exp_f32 v54, v54
    v_mfma_f32_32x32x4_2b_bf16 v[16:47], v[122:123], v[120:121], 0 cbsz:1 abid:0
    v_exp_f32 v55, v55
    v_exp_f32 v56, v56
    v_exp_f32 v57, v57
    v_exp_f32 v58, v58
    v_exp_f32 v59, v59
    v_exp_f32 v60, v60
    v_exp_f32 v61, v61
    v_exp_f32 v62, v62
    v_exp_f32 v63, v63
    v_smfmac_f32_32x32x32_bf16 v[80:95], v[136:139], v[48:55], v14
    v_exp_f32 v64, v64
    v_exp_f32 v65, v65
    v_exp_f32 v66, v66
    v_smfmac_f32_32x32x32_bf16 v[80:95], v[144:147], v[56:63], v14
    ds_read_b128 v[128:131], v1 offset:29696
    v_exp_f32 v67, v67
    v_exp_f32 v68, v68
    v_exp_f32 v69, v69
    v_exp_f32 v70, v70
    v_exp_f32 v71, v71
    v_mfma_f32_32x32x16_bf16 v[16:31], v[124:127], v[112:115], v[16:31]
    ds_read_b64_tr_b16 v[132:133], v4 offset:39424
    ds_read_b64_tr_b16 v[134:135], v5 offset:39424
    v_exp_f32 v72, v72
    v_exp_f32 v73, v73
    v_exp_f32 v74, v74
    v_exp_f32 v75, v75
    v_mfma_f32_32x32x16_bf16 v[32:47], v[124:127], v[116:119], v[32:47]
    s_waitcnt vmcnt(0)
    ds_write_b32 v13, v155 offset:33792
    v_exp_f32 v76, v76
    v_exp_f32 v77, v77
    v_exp_f32 v78, v78
    v_smfmac_f32_32x32x32_bf16 v[96:111], v[136:139], v[64:71], v14
    s_waitcnt lgkmcnt(1)
    v_exp_f32 v79, v79
    v_exp_f32 v16, v16
    v_exp_f32 v17, v17
    v_exp_f32 v18, v18
    v_smfmac_f32_32x32x32_bf16 v[96:111], v[144:147], v[72:79], v14
    ds_read_b64_tr_b16 v[144:145], v6 offset:40704
    ds_read_b64_tr_b16 v[146:147], v7 offset:40704
    v_exp_f32 v19, v19
    v_exp_f32 v20, v20
    v_exp_f32 v21, v21
    v_exp_f32 v22, v22
    v_mfma_f32_32x32x4_2b_bf16 v[48:79], v[122:123], v[120:121], 0 cbsz:1 abid:1
    v_exp_f32 v23, v23
    v_exp_f32 v24, v24
    v_exp_f32 v25, v25
    v_exp_f32 v26, v26
    v_exp_f32 v27, v27
    v_exp_f32 v28, v28
    v_exp_f32 v29, v29
    v_exp_f32 v30, v30
    v_exp_f32 v31, v31
    v_smfmac_f32_32x32x32_bf16 v[80:95], v[132:135], v[16:23], v14
    v_exp_f32 v32, v32
    v_exp_f32 v33, v33
    v_exp_f32 v34, v34
    v_smfmac_f32_32x32x32_bf16 v[80:95], v[140:143], v[24:31], v14
    ds_read_b128 v[124:127], v1 offset:30720
    ds_read_b32 v122, v2 offset:42240
    v_exp_f32 v35, v35
    v_exp_f32 v36, v36
    v_exp_f32 v37, v37
    v_exp_f32 v38, v38
    v_exp_f32 v39, v39
    v_mfma_f32_32x32x16_bf16 v[48:63], v[128:131], v[112:115], v[48:63]
    ds_read_b64_tr_b16 v[136:137], v4 offset:40704
    ds_read_b64_tr_b16 v[138:139], v5 offset:40704
    v_exp_f32 v40, v40
    v_exp_f32 v41, v41
    v_exp_f32 v42, v42
    v_exp_f32 v43, v43
    v_mfma_f32_32x32x16_bf16 v[64:79], v[128:131], v[116:119], v[64:79]
    v_exp_f32 v44, v44
    v_exp_f32 v45, v45
    v_exp_f32 v46, v46
    v_smfmac_f32_32x32x32_bf16 v[96:111], v[132:135], v[32:39], v14
    s_waitcnt lgkmcnt(0)
    v_exp_f32 v47, v47
    v_exp_f32 v48, v48
    v_exp_f32 v49, v49
    v_exp_f32 v50, v50
    v_smfmac_f32_32x32x32_bf16 v[96:111], v[140:143], v[40:47], v14
    s_setprio 1
    ds_read_b64_tr_b16 v[140:141], v6 offset:42240
    ds_read_b64_tr_b16 v[142:143], v7 offset:42240
    v_exp_f32 v51, v51
    v_exp_f32 v52, v52
    v_exp_f32 v53, v53
    v_exp_f32 v54, v54
    v_mfma_f32_32x32x4_2b_bf16 v[16:47], v[122:123], v[120:121], 0 cbsz:1 abid:0
    v_exp_f32 v55, v55
    v_exp_f32 v56, v56
    v_exp_f32 v57, v57
    v_exp_f32 v58, v58
    v_exp_f32 v59, v59
    v_exp_f32 v60, v60
    v_exp_f32 v61, v61
    v_exp_f32 v62, v62
    v_exp_f32 v63, v63
    v_smfmac_f32_32x32x32_bf16 v[80:95], v[136:139], v[48:55], v14
    v_exp_f32 v64, v64
    v_exp_f32 v65, v65
    v_exp_f32 v66, v66
    v_smfmac_f32_32x32x32_bf16 v[80:95], v[144:147], v[56:63], v14
    ds_read_b128 v[128:131], v1 offset:31744
    v_exp_f32 v67, v67
    v_exp_f32 v68, v68
    v_exp_f32 v69, v69
    v_exp_f32 v70, v70
    v_exp_f32 v71, v71
    v_mfma_f32_32x32x16_bf16 v[16:31], v[124:127], v[112:115], v[16:31]
    ds_read_b64_tr_b16 v[132:133], v4 offset:42240
    ds_read_b64_tr_b16 v[134:135], v5 offset:42240
    v_exp_f32 v72, v72
    v_exp_f32 v73, v73
    v_exp_f32 v74, v74
    v_exp_f32 v75, v75
    v_mfma_f32_32x32x16_bf16 v[32:47], v[124:127], v[116:119], v[32:47]
    v_exp_f32 v76, v76
    v_exp_f32 v77, v77
    v_exp_f32 v78, v78
    v_smfmac_f32_32x32x32_bf16 v[96:111], v[136:139], v[64:71], v14
    s_waitcnt lgkmcnt(0)
    v_exp_f32 v79, v79
    v_exp_f32 v16, v16
    v_exp_f32 v17, v17
    v_exp_f32 v18, v18
    v_smfmac_f32_32x32x32_bf16 v[96:111], v[144:147], v[72:79], v14
    s_setprio 0
    ds_read_b64_tr_b16 v[144:145], v6 offset:43520
    ds_read_b64_tr_b16 v[146:147], v7 offset:43520
    v_exp_f32 v19, v19
    v_exp_f32 v20, v20
    v_exp_f32 v21, v21
    v_exp_f32 v22, v22
    v_mfma_f32_32x32x4_2b_bf16 v[48:79], v[122:123], v[120:121], 0 cbsz:1 abid:1
    v_exp_f32 v23, v23
    v_exp_f32 v24, v24
    v_exp_f32 v25, v25
    v_exp_f32 v26, v26
    v_exp_f32 v27, v27
    v_exp_f32 v28, v28
    v_exp_f32 v29, v29
    v_exp_f32 v30, v30
    v_exp_f32 v31, v31
    v_smfmac_f32_32x32x32_bf16 v[80:95], v[132:135], v[16:23], v14
    v_exp_f32 v32, v32
    v_exp_f32 v33, v33
    v_exp_f32 v34, v34
    v_smfmac_f32_32x32x32_bf16 v[80:95], v[140:143], v[24:31], v14
    s_barrier
    s_setprio 3
    ds_read_b128 v[124:127], v1 offset:32768
    ds_read_b32 v122, v3 offset:0
    v_exp_f32 v35, v35
    v_exp_f32 v36, v36
    v_exp_f32 v37, v37
    v_exp_f32 v38, v38
    v_exp_f32 v39, v39
    v_mfma_f32_32x32x16_bf16 v[48:63], v[128:131], v[112:115], v[48:63]
    ds_read_b64_tr_b16 v[136:137], v4 offset:43520
    ds_read_b64_tr_b16 v[138:139], v5 offset:43520
    v_exp_f32 v40, v40
    v_exp_f32 v41, v41
    v_exp_f32 v42, v42
    v_exp_f32 v43, v43
    v_mfma_f32_32x32x16_bf16 v[64:79], v[128:131], v[116:119], v[64:79]
    v_exp_f32 v44, v44
    v_exp_f32 v45, v45
    v_exp_f32 v46, v46
    v_smfmac_f32_32x32x32_bf16 v[96:111], v[132:135], v[32:39], v14
    s_waitcnt lgkmcnt(0)
    v_exp_f32 v47, v47
    v_exp_f32 v48, v48
    v_exp_f32 v49, v49
    v_exp_f32 v50, v50
    v_smfmac_f32_32x32x32_bf16 v[96:111], v[140:143], v[40:47], v14
    ds_read_b64_tr_b16 v[140:141], v10 offset:0
    ds_read_b64_tr_b16 v[142:143], v11 offset:0
    v_exp_f32 v51, v51
    v_exp_f32 v52, v52
    v_exp_f32 v53, v53
    v_exp_f32 v54, v54
    v_mfma_f32_32x32x4_2b_bf16 v[16:47], v[122:123], v[120:121], 0 cbsz:1 abid:0
    v_exp_f32 v55, v55
    v_exp_f32 v56, v56
    v_exp_f32 v57, v57
    v_exp_f32 v58, v58
    v_exp_f32 v59, v59
    v_exp_f32 v60, v60
    v_exp_f32 v61, v61
    v_exp_f32 v62, v62
    v_exp_f32 v63, v63
    v_smfmac_f32_32x32x32_bf16 v[80:95], v[136:139], v[48:55], v14
    v_exp_f32 v64, v64
    v_exp_f32 v65, v65
    v_exp_f32 v66, v66
    v_smfmac_f32_32x32x32_bf16 v[80:95], v[144:147], v[56:63], v14
    ds_read_b128 v[128:131], v1 offset:33792
    v_exp_f32 v67, v67
    v_exp_f32 v68, v68
    v_exp_f32 v69, v69
    v_exp_f32 v70, v70
    v_exp_f32 v71, v71
    v_mfma_f32_32x32x16_bf16 v[16:31], v[124:127], v[112:115], v[16:31]
    ds_read_b64_tr_b16 v[132:133], v8 offset:0
    ds_read_b64_tr_b16 v[134:135], v9 offset:0
    v_exp_f32 v72, v72
    v_exp_f32 v73, v73
    v_exp_f32 v74, v74
    v_exp_f32 v75, v75
    v_mfma_f32_32x32x16_bf16 v[32:47], v[124:127], v[116:119], v[32:47]
    v_exp_f32 v76, v76
    v_exp_f32 v77, v77
    v_exp_f32 v78, v78
    v_smfmac_f32_32x32x32_bf16 v[96:111], v[136:139], v[64:71], v14
    s_waitcnt lgkmcnt(0)
    v_exp_f32 v79, v79
    v_exp_f32 v16, v16
    v_exp_f32 v17, v17
    v_exp_f32 v18, v18
    v_smfmac_f32_32x32x32_bf16 v[96:111], v[144:147], v[72:79], v14
    ds_read_b64_tr_b16 v[144:145], v10 offset:1280
    ds_read_b64_tr_b16 v[146:147], v11 offset:1280
    v_exp_f32 v19, v19
    v_exp_f32 v20, v20
    v_exp_f32 v21, v21
    v_exp_f32 v22, v22
    v_mfma_f32_32x32x4_2b_bf16 v[48:79], v[122:123], v[120:121], 0 cbsz:1 abid:1
    v_exp_f32 v23, v23
    v_exp_f32 v24, v24
    v_exp_f32 v25, v25
    v_exp_f32 v26, v26
    v_exp_f32 v27, v27
    v_exp_f32 v28, v28
    v_exp_f32 v29, v29
    v_exp_f32 v30, v30
    v_exp_f32 v31, v31
    v_smfmac_f32_32x32x32_bf16 v[80:95], v[132:135], v[16:23], v14
    v_exp_f32 v32, v32
    v_exp_f32 v33, v33
    v_exp_f32 v34, v34
    v_smfmac_f32_32x32x32_bf16 v[80:95], v[140:143], v[24:31], v14
    ds_read_b128 v[124:127], v1 offset:34816
    ds_read_b32 v122, v3 offset:2816
    v_exp_f32 v35, v35
    v_exp_f32 v36, v36
    v_exp_f32 v37, v37
    v_exp_f32 v38, v38
    v_exp_f32 v39, v39
    v_mfma_f32_32x32x16_bf16 v[48:63], v[128:131], v[112:115], v[48:63]
    ds_read_b64_tr_b16 v[136:137], v8 offset:1280
    ds_read_b64_tr_b16 v[138:139], v9 offset:1280
    v_exp_f32 v40, v40
    v_exp_f32 v41, v41
    v_exp_f32 v42, v42
    v_exp_f32 v43, v43
    v_mfma_f32_32x32x16_bf16 v[64:79], v[128:131], v[116:119], v[64:79]
    v_exp_f32 v44, v44
    v_exp_f32 v45, v45
    v_exp_f32 v46, v46
    v_smfmac_f32_32x32x32_bf16 v[96:111], v[132:135], v[32:39], v14
    s_waitcnt lgkmcnt(0)
    v_exp_f32 v47, v47
    v_exp_f32 v48, v48
    v_exp_f32 v49, v49
    v_exp_f32 v50, v50
    v_smfmac_f32_32x32x32_bf16 v[96:111], v[140:143], v[40:47], v14
    ds_read_b64_tr_b16 v[140:141], v10 offset:2816
    ds_read_b64_tr_b16 v[142:143], v11 offset:2816
    v_exp_f32 v51, v51
    v_exp_f32 v52, v52
    v_exp_f32 v53, v53
    v_exp_f32 v54, v54
    v_mfma_f32_32x32x4_2b_bf16 v[16:47], v[122:123], v[120:121], 0 cbsz:1 abid:0
    v_exp_f32 v55, v55
    v_exp_f32 v56, v56
    v_exp_f32 v57, v57
    v_exp_f32 v58, v58
    v_exp_f32 v59, v59
    v_exp_f32 v60, v60
    v_exp_f32 v61, v61
    v_exp_f32 v62, v62
    v_exp_f32 v63, v63
    v_smfmac_f32_32x32x32_bf16 v[80:95], v[136:139], v[48:55], v14
    v_exp_f32 v64, v64
    v_exp_f32 v65, v65
    v_exp_f32 v66, v66
    v_smfmac_f32_32x32x32_bf16 v[80:95], v[144:147], v[56:63], v14
    ds_read_b128 v[128:131], v1 offset:35840
    v_exp_f32 v67, v67
    v_exp_f32 v68, v68
    v_exp_f32 v69, v69
    v_exp_f32 v70, v70
    v_exp_f32 v71, v71
    v_mfma_f32_32x32x16_bf16 v[16:31], v[124:127], v[112:115], v[16:31]
    ds_read_b64_tr_b16 v[132:133], v8 offset:2816
    ds_read_b64_tr_b16 v[134:135], v9 offset:2816
    v_exp_f32 v72, v72
    v_exp_f32 v73, v73
    v_exp_f32 v74, v74
    v_exp_f32 v75, v75
    v_mfma_f32_32x32x16_bf16 v[32:47], v[124:127], v[116:119], v[32:47]
    v_exp_f32 v76, v76
    v_exp_f32 v77, v77
    v_exp_f32 v78, v78
    v_smfmac_f32_32x32x32_bf16 v[96:111], v[136:139], v[64:71], v14
    s_waitcnt lgkmcnt(0)
    v_exp_f32 v79, v79
    v_exp_f32 v16, v16
    v_exp_f32 v17, v17
    v_exp_f32 v18, v18
    v_smfmac_f32_32x32x32_bf16 v[96:111], v[144:147], v[72:79], v14
    ds_read_b64_tr_b16 v[144:145], v10 offset:4096
    ds_read_b64_tr_b16 v[146:147], v11 offset:4096
    v_exp_f32 v19, v19
    v_exp_f32 v20, v20
    v_exp_f32 v21, v21
    v_exp_f32 v22, v22
    v_mfma_f32_32x32x4_2b_bf16 v[48:79], v[122:123], v[120:121], 0 cbsz:1 abid:1
    v_exp_f32 v23, v23
    v_exp_f32 v24, v24
    v_exp_f32 v25, v25
    v_exp_f32 v26, v26
    v_exp_f32 v27, v27
    v_exp_f32 v28, v28
    v_exp_f32 v29, v29
    v_exp_f32 v30, v30
    v_exp_f32 v31, v31
    v_smfmac_f32_32x32x32_bf16 v[80:95], v[132:135], v[16:23], v14
    v_exp_f32 v32, v32
    v_exp_f32 v33, v33
    v_exp_f32 v34, v34
    v_smfmac_f32_32x32x32_bf16 v[80:95], v[140:143], v[24:31], v14
    ds_read_b128 v[124:127], v1 offset:36864
    ds_read_b32 v122, v3 offset:5632
    v_exp_f32 v35, v35
    v_exp_f32 v36, v36
    v_exp_f32 v37, v37
    v_exp_f32 v38, v38
    v_exp_f32 v39, v39
    v_mfma_f32_32x32x16_bf16 v[48:63], v[128:131], v[112:115], v[48:63]
    ds_read_b64_tr_b16 v[136:137], v8 offset:4096
    ds_read_b64_tr_b16 v[138:139], v9 offset:4096
    v_exp_f32 v40, v40
    v_exp_f32 v41, v41
    v_exp_f32 v42, v42
    v_exp_f32 v43, v43
    v_mfma_f32_32x32x16_bf16 v[64:79], v[128:131], v[116:119], v[64:79]
    v_exp_f32 v44, v44
    v_exp_f32 v45, v45
    v_exp_f32 v46, v46
    v_smfmac_f32_32x32x32_bf16 v[96:111], v[132:135], v[32:39], v14
    s_waitcnt lgkmcnt(0)
    v_exp_f32 v47, v47
    v_exp_f32 v48, v48
    v_exp_f32 v49, v49
    v_exp_f32 v50, v50
    v_smfmac_f32_32x32x32_bf16 v[96:111], v[140:143], v[40:47], v14
    ds_read_b64_tr_b16 v[140:141], v10 offset:5632
    ds_read_b64_tr_b16 v[142:143], v11 offset:5632
    v_exp_f32 v51, v51
    v_exp_f32 v52, v52
    v_exp_f32 v53, v53
    v_exp_f32 v54, v54
    v_mfma_f32_32x32x4_2b_bf16 v[16:47], v[122:123], v[120:121], 0 cbsz:1 abid:0
    v_exp_f32 v55, v55
    v_exp_f32 v56, v56
    v_exp_f32 v57, v57
    v_exp_f32 v58, v58
    v_exp_f32 v59, v59
    v_exp_f32 v60, v60
    v_exp_f32 v61, v61
    v_exp_f32 v62, v62
    v_exp_f32 v63, v63
    v_smfmac_f32_32x32x32_bf16 v[80:95], v[136:139], v[48:55], v14
    v_exp_f32 v64, v64
    v_exp_f32 v65, v65
    v_exp_f32 v66, v66
    v_smfmac_f32_32x32x32_bf16 v[80:95], v[144:147], v[56:63], v14
    ds_read_b128 v[128:131], v1 offset:37888
    v_exp_f32 v67, v67
    v_exp_f32 v68, v68
    v_exp_f32 v69, v69
    v_exp_f32 v70, v70
    v_exp_f32 v71, v71
    v_mfma_f32_32x32x16_bf16 v[16:31], v[124:127], v[112:115], v[16:31]
    ds_read_b64_tr_b16 v[132:133], v8 offset:5632
    ds_read_b64_tr_b16 v[134:135], v9 offset:5632
    v_exp_f32 v72, v72
    v_exp_f32 v73, v73
    v_exp_f32 v74, v74
    v_exp_f32 v75, v75
    v_mfma_f32_32x32x16_bf16 v[32:47], v[124:127], v[116:119], v[32:47]
    v_exp_f32 v76, v76
    v_exp_f32 v77, v77
    v_exp_f32 v78, v78
    v_smfmac_f32_32x32x32_bf16 v[96:111], v[136:139], v[64:71], v14
    s_waitcnt lgkmcnt(0)
    v_exp_f32 v79, v79
    v_exp_f32 v16, v16
    v_exp_f32 v17, v17
    v_exp_f32 v18, v18
    v_smfmac_f32_32x32x32_bf16 v[96:111], v[144:147], v[72:79], v14
    ds_read_b64_tr_b16 v[144:145], v10 offset:6912
    ds_read_b64_tr_b16 v[146:147], v11 offset:6912
    v_exp_f32 v19, v19
    v_exp_f32 v20, v20
    v_exp_f32 v21, v21
    v_exp_f32 v22, v22
    v_mfma_f32_32x32x4_2b_bf16 v[48:79], v[122:123], v[120:121], 0 cbsz:1 abid:1
    v_exp_f32 v23, v23
    v_exp_f32 v24, v24
    v_exp_f32 v25, v25
    v_exp_f32 v26, v26
    v_exp_f32 v27, v27
    v_exp_f32 v28, v28
    v_exp_f32 v29, v29
    v_exp_f32 v30, v30
    v_exp_f32 v31, v31
    v_smfmac_f32_32x32x32_bf16 v[80:95], v[132:135], v[16:23], v14
    v_exp_f32 v32, v32
    v_exp_f32 v33, v33
    v_exp_f32 v34, v34
    v_smfmac_f32_32x32x32_bf16 v[80:95], v[140:143], v[24:31], v14
    ds_read_b128 v[124:127], v1 offset:38912
    ds_read_b32 v122, v3 offset:8448
    v_exp_f32 v35, v35
    v_exp_f32 v36, v36
    v_exp_f32 v37, v37
    v_exp_f32 v38, v38
    v_exp_f32 v39, v39
    v_mfma_f32_32x32x16_bf16 v[48:63], v[128:131], v[112:115], v[48:63]
    ds_read_b64_tr_b16 v[136:137], v8 offset:6912
    ds_read_b64_tr_b16 v[138:139], v9 offset:6912
    v_exp_f32 v40, v40
    v_exp_f32 v41, v41
    v_exp_f32 v42, v42
    v_exp_f32 v43, v43
    v_mfma_f32_32x32x16_bf16 v[64:79], v[128:131], v[116:119], v[64:79]
    v_exp_f32 v44, v44
    v_exp_f32 v45, v45
    v_exp_f32 v46, v46
    v_smfmac_f32_32x32x32_bf16 v[96:111], v[132:135], v[32:39], v14
    s_waitcnt lgkmcnt(0)
    v_exp_f32 v47, v47
    v_exp_f32 v48, v48
    v_exp_f32 v49, v49
    v_exp_f32 v50, v50
    v_smfmac_f32_32x32x32_bf16 v[96:111], v[140:143], v[40:47], v14
    ds_read_b64_tr_b16 v[140:141], v10 offset:8448
    ds_read_b64_tr_b16 v[142:143], v11 offset:8448
    v_exp_f32 v51, v51
    v_exp_f32 v52, v52
    v_exp_f32 v53, v53
    v_exp_f32 v54, v54
    v_mfma_f32_32x32x4_2b_bf16 v[16:47], v[122:123], v[120:121], 0 cbsz:1 abid:0
    v_exp_f32 v55, v55
    v_exp_f32 v56, v56
    v_exp_f32 v57, v57
    v_exp_f32 v58, v58
    v_exp_f32 v59, v59
    v_exp_f32 v60, v60
    v_exp_f32 v61, v61
    v_exp_f32 v62, v62
    v_exp_f32 v63, v63
    v_smfmac_f32_32x32x32_bf16 v[80:95], v[136:139], v[48:55], v14
    v_exp_f32 v64, v64
    v_exp_f32 v65, v65
    v_exp_f32 v66, v66
    v_smfmac_f32_32x32x32_bf16 v[80:95], v[144:147], v[56:63], v14
    ds_read_b128 v[128:131], v1 offset:39936
    v_exp_f32 v67, v67
    v_exp_f32 v68, v68
    v_exp_f32 v69, v69
    v_exp_f32 v70, v70
    v_exp_f32 v71, v71
    v_mfma_f32_32x32x16_bf16 v[16:31], v[124:127], v[112:115], v[16:31]
    ds_read_b64_tr_b16 v[132:133], v8 offset:8448
    ds_read_b64_tr_b16 v[134:135], v9 offset:8448
    v_exp_f32 v72, v72
    v_exp_f32 v73, v73
    v_exp_f32 v74, v74
    v_exp_f32 v75, v75
    v_mfma_f32_32x32x16_bf16 v[32:47], v[124:127], v[116:119], v[32:47]
    v_exp_f32 v76, v76
    v_exp_f32 v77, v77
    v_exp_f32 v78, v78
    v_smfmac_f32_32x32x32_bf16 v[96:111], v[136:139], v[64:71], v14
    s_waitcnt lgkmcnt(0)
    v_exp_f32 v79, v79
    v_exp_f32 v16, v16
    v_exp_f32 v17, v17
    v_exp_f32 v18, v18
    v_smfmac_f32_32x32x32_bf16 v[96:111], v[144:147], v[72:79], v14
    ds_read_b64_tr_b16 v[144:145], v10 offset:9728
    ds_read_b64_tr_b16 v[146:147], v11 offset:9728
    v_exp_f32 v19, v19
    v_exp_f32 v20, v20
    v_exp_f32 v21, v21
    v_exp_f32 v22, v22
    v_mfma_f32_32x32x4_2b_bf16 v[48:79], v[122:123], v[120:121], 0 cbsz:1 abid:1
    v_exp_f32 v23, v23
    v_exp_f32 v24, v24
    v_exp_f32 v25, v25
    v_exp_f32 v26, v26
    v_exp_f32 v27, v27
    v_exp_f32 v28, v28
    v_exp_f32 v29, v29
    v_exp_f32 v30, v30
    v_exp_f32 v31, v31
    v_smfmac_f32_32x32x32_bf16 v[80:95], v[132:135], v[16:23], v14
    v_exp_f32 v32, v32
    v_exp_f32 v33, v33
    v_exp_f32 v34, v34
    v_smfmac_f32_32x32x32_bf16 v[80:95], v[140:143], v[24:31], v14
    ds_read_b128 v[124:127], v1 offset:40960
    ds_read_b32 v122, v3 offset:11264
    v_exp_f32 v35, v35
    v_exp_f32 v36, v36
    v_exp_f32 v37, v37
    v_exp_f32 v38, v38
    v_exp_f32 v39, v39
    v_mfma_f32_32x32x16_bf16 v[48:63], v[128:131], v[112:115], v[48:63]
    ds_read_b64_tr_b16 v[136:137], v8 offset:9728
    ds_read_b64_tr_b16 v[138:139], v9 offset:9728
    v_exp_f32 v40, v40
    v_exp_f32 v41, v41
    v_exp_f32 v42, v42
    v_exp_f32 v43, v43
    v_mfma_f32_32x32x16_bf16 v[64:79], v[128:131], v[116:119], v[64:79]
    v_exp_f32 v44, v44
    v_exp_f32 v45, v45
    v_exp_f32 v46, v46
    v_smfmac_f32_32x32x32_bf16 v[96:111], v[132:135], v[32:39], v14
    s_waitcnt lgkmcnt(0)
    v_exp_f32 v47, v47
    v_exp_f32 v48, v48
    v_exp_f32 v49, v49
    v_exp_f32 v50, v50
    v_smfmac_f32_32x32x32_bf16 v[96:111], v[140:143], v[40:47], v14
    ds_read_b64_tr_b16 v[140:141], v10 offset:11264
    ds_read_b64_tr_b16 v[142:143], v11 offset:11264
    v_exp_f32 v51, v51
    v_exp_f32 v52, v52
    v_exp_f32 v53, v53
    v_exp_f32 v54, v54
    v_mfma_f32_32x32x4_2b_bf16 v[16:47], v[122:123], v[120:121], 0 cbsz:1 abid:0
    v_exp_f32 v55, v55
    v_exp_f32 v56, v56
    v_exp_f32 v57, v57
    v_exp_f32 v58, v58
    v_exp_f32 v59, v59
    v_exp_f32 v60, v60
    v_exp_f32 v61, v61
    v_exp_f32 v62, v62
    v_exp_f32 v63, v63
    v_smfmac_f32_32x32x32_bf16 v[80:95], v[136:139], v[48:55], v14
    v_exp_f32 v64, v64
    v_exp_f32 v65, v65
    v_exp_f32 v66, v66
    v_smfmac_f32_32x32x32_bf16 v[80:95], v[144:147], v[56:63], v14
    ds_read_b128 v[128:131], v1 offset:41984
    v_exp_f32 v67, v67
    v_exp_f32 v68, v68
    v_exp_f32 v69, v69
    v_exp_f32 v70, v70
    v_exp_f32 v71, v71
    v_mfma_f32_32x32x16_bf16 v[16:31], v[124:127], v[112:115], v[16:31]
    ds_read_b64_tr_b16 v[132:133], v8 offset:11264
    ds_read_b64_tr_b16 v[134:135], v9 offset:11264
    v_exp_f32 v72, v72
    v_exp_f32 v73, v73
    v_exp_f32 v74, v74
    v_exp_f32 v75, v75
    v_mfma_f32_32x32x16_bf16 v[32:47], v[124:127], v[116:119], v[32:47]
    v_exp_f32 v76, v76
    v_exp_f32 v77, v77
    v_exp_f32 v78, v78
    v_smfmac_f32_32x32x32_bf16 v[96:111], v[136:139], v[64:71], v14
    s_waitcnt lgkmcnt(0)
    v_exp_f32 v79, v79
    v_exp_f32 v16, v16
    v_exp_f32 v17, v17
    v_exp_f32 v18, v18
    v_smfmac_f32_32x32x32_bf16 v[96:111], v[144:147], v[72:79], v14
    ds_read_b64_tr_b16 v[144:145], v10 offset:12544
    ds_read_b64_tr_b16 v[146:147], v11 offset:12544
    v_exp_f32 v19, v19
    v_exp_f32 v20, v20
    v_exp_f32 v21, v21
    v_exp_f32 v22, v22
    v_mfma_f32_32x32x4_2b_bf16 v[48:79], v[122:123], v[120:121], 0 cbsz:1 abid:1
    v_exp_f32 v23, v23
    v_exp_f32 v24, v24
    v_exp_f32 v25, v25
    v_exp_f32 v26, v26
    v_exp_f32 v27, v27
    v_exp_f32 v28, v28
    v_exp_f32 v29, v29
    v_exp_f32 v30, v30
    v_exp_f32 v31, v31
    v_smfmac_f32_32x32x32_bf16 v[80:95], v[132:135], v[16:23], v14
    v_exp_f32 v32, v32
    v_exp_f32 v33, v33
    v_exp_f32 v34, v34
    v_smfmac_f32_32x32x32_bf16 v[80:95], v[140:143], v[24:31], v14
    ds_read_b128 v[124:127], v1 offset:43008
    ds_read_b32 v122, v3 offset:14080
    v_exp_f32 v35, v35
    v_exp_f32 v36, v36
    v_exp_f32 v37, v37
    v_exp_f32 v38, v38
    v_exp_f32 v39, v39
    v_mfma_f32_32x32x16_bf16 v[48:63], v[128:131], v[112:115], v[48:63]
L_t3:
    s_cbranch_execz L_ret
    ds_read_b64_tr_b16 v[136:137], v8 offset:12544
    ds_read_b64_tr_b16 v[138:139], v9 offset:12544
    v_exp_f32 v40, v40
    v_exp_f32 v41, v41
    v_exp_f32 v42, v42
    v_exp_f32 v43, v43
    v_mfma_f32_32x32x16_bf16 v[64:79], v[128:131], v[116:119], v[64:79]
    v_exp_f32 v44, v44
    v_exp_f32 v45, v45
    v_exp_f32 v46, v46
    v_smfmac_f32_32x32x32_bf16 v[96:111], v[132:135], v[32:39], v14
    s_waitcnt lgkmcnt(0)
    v_exp_f32 v47, v47
    v_exp_f32 v48, v48
    v_exp_f32 v49, v49
    v_exp_f32 v50, v50
    v_smfmac_f32_32x32x32_bf16 v[96:111], v[140:143], v[40:47], v14
    ds_read_b64_tr_b16 v[140:141], v10 offset:14080
    ds_read_b64_tr_b16 v[142:143], v11 offset:14080
    v_exp_f32 v51, v51
    v_exp_f32 v52, v52
    v_exp_f32 v53, v53
    v_exp_f32 v54, v54
    v_mfma_f32_32x32x4_2b_bf16 v[16:47], v[122:123], v[120:121], 0 cbsz:1 abid:0
    v_exp_f32 v55, v55
    v_exp_f32 v56, v56
    v_exp_f32 v57, v57
    v_exp_f32 v58, v58
    v_exp_f32 v59, v59
    v_exp_f32 v60, v60
    v_exp_f32 v61, v61
    v_exp_f32 v62, v62
    v_exp_f32 v63, v63
    v_smfmac_f32_32x32x32_bf16 v[80:95], v[136:139], v[48:55], v14
    v_exp_f32 v64, v64
    v_exp_f32 v65, v65
    v_exp_f32 v66, v66
    v_smfmac_f32_32x32x32_bf16 v[80:95], v[144:147], v[56:63], v14
    ds_read_b128 v[128:131], v1 offset:44032
    v_exp_f32 v67, v67
    v_exp_f32 v68, v68
    v_exp_f32 v69, v69
    v_exp_f32 v70, v70
    v_exp_f32 v71, v71
    v_mfma_f32_32x32x16_bf16 v[16:31], v[124:127], v[112:115], v[16:31]
    ds_read_b64_tr_b16 v[132:133], v8 offset:14080
    ds_read_b64_tr_b16 v[134:135], v9 offset:14080
    v_exp_f32 v72, v72
    v_exp_f32 v73, v73
    v_exp_f32 v74, v74
    v_exp_f32 v75, v75
    v_mfma_f32_32x32x16_bf16 v[32:47], v[124:127], v[116:119], v[32:47]
    v_exp_f32 v76, v76
    v_exp_f32 v77, v77
    v_exp_f32 v78, v78
    v_smfmac_f32_32x32x32_bf16 v[96:111], v[136:139], v[64:71], v14
    s_waitcnt lgkmcnt(0)
    v_exp_f32 v79, v79
    v_exp_f32 v16, v16
    v_exp_f32 v17, v17
    v_exp_f32 v18, v18
    v_smfmac_f32_32x32x32_bf16 v[96:111], v[144:147], v[72:79], v14
    ds_read_b64_tr_b16 v[144:145], v10 offset:15360
    ds_read_b64_tr_b16 v[146:147], v11 offset:15360
    v_exp_f32 v19, v19
    v_exp_f32 v20, v20
    v_exp_f32 v21, v21
    v_exp_f32 v22, v22
    v_mfma_f32_32x32x4_2b_bf16 v[48:79], v[122:123], v[120:121], 0 cbsz:1 abid:1
    v_exp_f32 v23, v23
    v_exp_f32 v24, v24
    v_exp_f32 v25, v25
    v_exp_f32 v26, v26
    v_exp_f32 v27, v27
    v_exp_f32 v28, v28
    v_exp_f32 v29, v29
    v_exp_f32 v30, v30
    v_exp_f32 v31, v31
    v_smfmac_f32_32x32x32_bf16 v[80:95], v[132:135], v[16:23], v14
    v_exp_f32 v32, v32
    v_exp_f32 v33, v33
    v_exp_f32 v34, v34
    v_smfmac_f32_32x32x32_bf16 v[80:95], v[140:143], v[24:31], v14
    ds_read_b128 v[124:127], v1 offset:45056
    ds_read_b32 v122, v3 offset:16896
    v_exp_f32 v35, v35
    v_exp_f32 v36, v36
    v_exp_f32 v37, v37
    v_exp_f32 v38, v38
    v_exp_f32 v39, v39
    v_mfma_f32_32x32x16_bf16 v[48:63], v[128:131], v[112:115], v[48:63]
    ds_read_b64_tr_b16 v[136:137], v8 offset:15360
    ds_read_b64_tr_b16 v[138:139], v9 offset:15360
    v_exp_f32 v40, v40
    v_exp_f32 v41, v41
    v_exp_f32 v42, v42
    v_exp_f32 v43, v43
    v_mfma_f32_32x32x16_bf16 v[64:79], v[128:131], v[116:119], v[64:79]
    v_exp_f32 v44, v44
    v_exp_f32 v45, v45
    v_exp_f32 v46, v46
    v_smfmac_f32_32x32x32_bf16 v[96:111], v[132:135], v[32:39], v14
    s_waitcnt lgkmcnt(0)
    v_exp_f32 v47, v47
    v_exp_f32 v48, v48
    v_exp_f32 v49, v49
    v_exp_f32 v50, v50
    v_smfmac_f32_32x32x32_bf16 v[96:111], v[140:143], v[40:47], v14
    ds_read_b64_tr_b16 v[140:141], v10 offset:16896
    ds_read_b64_tr_b16 v[142:143], v11 offset:16896
    v_exp_f32 v51, v51
    v_exp_f32 v52, v52
    v_exp_f32 v53, v53
    v_exp_f32 v54, v54
    v_mfma_f32_32x32x4_2b_bf16 v[16:47], v[122:123], v[120:121], 0 cbsz:1 abid:0
    v_exp_f32 v55, v55
    v_exp_f32 v56, v56
    v_exp_f32 v57, v57
    v_exp_f32 v58, v58
    v_exp_f32 v59, v59
    v_exp_f32 v60, v60
    v_exp_f32 v61, v61
    v_exp_f32 v62, v62
    v_exp_f32 v63, v63
    v_smfmac_f32_32x32x32_bf16 v[80:95], v[136:139], v[48:55], v14
    v_exp_f32 v64, v64
    v_exp_f32 v65, v65
    v_exp_f32 v66, v66
    v_smfmac_f32_32x32x32_bf16 v[80:95], v[144:147], v[56:63], v14
    ds_read_b128 v[128:131], v1 offset:46080
    v_exp_f32 v67, v67
    v_exp_f32 v68, v68
    v_exp_f32 v69, v69
    v_exp_f32 v70, v70
    v_exp_f32 v71, v71
    v_mfma_f32_32x32x16_bf16 v[16:31], v[124:127], v[112:115], v[16:31]
    ds_read_b64_tr_b16 v[132:133], v8 offset:16896
    ds_read_b64_tr_b16 v[134:135], v9 offset:16896
    v_exp_f32 v72, v72
    v_exp_f32 v73, v73
    v_exp_f32 v74, v74
    v_exp_f32 v75, v75
    v_mfma_f32_32x32x16_bf16 v[32:47], v[124:127], v[116:119], v[32:47]
    v_exp_f32 v76, v76
    v_exp_f32 v77, v77
    v_exp_f32 v78, v78
    v_smfmac_f32_32x32x32_bf16 v[96:111], v[136:139], v[64:71], v14
    s_waitcnt lgkmcnt(0)
    v_exp_f32 v79, v79
    v_exp_f32 v16, v16
    v_exp_f32 v17, v17
    v_exp_f32 v18, v18
    v_smfmac_f32_32x32x32_bf16 v[96:111], v[144:147], v[72:79], v14
    ds_read_b64_tr_b16 v[144:145], v10 offset:18176
    ds_read_b64_tr_b16 v[146:147], v11 offset:18176
    v_exp_f32 v19, v19
    v_exp_f32 v20, v20
    v_exp_f32 v21, v21
    v_exp_f32 v22, v22
    v_mfma_f32_32x32x4_2b_bf16 v[48:79], v[122:123], v[120:121], 0 cbsz:1 abid:1
    v_exp_f32 v23, v23
    v_exp_f32 v24, v24
    v_exp_f32 v25, v25
    v_exp_f32 v26, v26
    v_exp_f32 v27, v27
    v_exp_f32 v28, v28
    v_exp_f32 v29, v29
    v_exp_f32 v30, v30
    v_exp_f32 v31, v31
    v_smfmac_f32_32x32x32_bf16 v[80:95], v[132:135], v[16:23], v14
    v_exp_f32 v32, v32
    v_exp_f32 v33, v33
    v_exp_f32 v34, v34
    v_smfmac_f32_32x32x32_bf16 v[80:95], v[140:143], v[24:31], v14
    ds_read_b128 v[124:127], v1 offset:47104
    ds_read_b32 v122, v3 offset:19712
    v_exp_f32 v35, v35
    v_exp_f32 v36, v36
    v_exp_f32 v37, v37
    v_exp_f32 v38, v38
    v_exp_f32 v39, v39
    v_mfma_f32_32x32x16_bf16 v[48:63], v[128:131], v[112:115], v[48:63]
    ds_read_b64_tr_b16 v[136:137], v8 offset:18176
    ds_read_b64_tr_b16 v[138:139], v9 offset:18176
    v_exp_f32 v40, v40
    v_exp_f32 v41, v41
    v_exp_f32 v42, v42
    v_exp_f32 v43, v43
    v_mfma_f32_32x32x16_bf16 v[64:79], v[128:131], v[116:119], v[64:79]
    v_exp_f32 v44, v44
    v_exp_f32 v45, v45
    v_exp_f32 v46, v46
    v_smfmac_f32_32x32x32_bf16 v[96:111], v[132:135], v[32:39], v14
    s_waitcnt lgkmcnt(0)
    v_exp_f32 v47, v47
    v_exp_f32 v48, v48
    v_exp_f32 v49, v49
    v_exp_f32 v50, v50
    v_smfmac_f32_32x32x32_bf16 v[96:111], v[140:143], v[40:47], v14
    ds_read_b64_tr_b16 v[140:141], v10 offset:19712
    ds_read_b64_tr_b16 v[142:143], v11 offset:19712
    v_exp_f32 v51, v51
    v_exp_f32 v52, v52
    v_exp_f32 v53, v53
    v_exp_f32 v54, v54
    v_mfma_f32_32x32x4_2b_bf16 v[16:47], v[122:123], v[120:121], 0 cbsz:1 abid:0
    v_exp_f32 v55, v55
    v_exp_f32 v56, v56
    v_exp_f32 v57, v57
    v_exp_f32 v58, v58
    v_exp_f32 v59, v59
    v_exp_f32 v60, v60
    v_exp_f32 v61, v61
    v_exp_f32 v62, v62
    v_exp_f32 v63, v63
    v_smfmac_f32_32x32x32_bf16 v[80:95], v[136:139], v[48:55], v14
    v_exp_f32 v64, v64
    v_exp_f32 v65, v65
    v_exp_f32 v66, v66
    v_smfmac_f32_32x32x32_bf16 v[80:95], v[144:147], v[56:63], v14
    ds_read_b128 v[128:131], v1 offset:48128
    v_exp_f32 v67, v67
    v_exp_f32 v68, v68
    v_exp_f32 v69, v69
    v_exp_f32 v70, v70
    v_exp_f32 v71, v71
    v_mfma_f32_32x32x16_bf16 v[16:31], v[124:127], v[112:115], v[16:31]
    ds_read_b64_tr_b16 v[132:133], v8 offset:19712
    ds_read_b64_tr_b16 v[134:135], v9 offset:19712
    v_exp_f32 v72, v72
    v_exp_f32 v73, v73
    v_exp_f32 v74, v74
    v_exp_f32 v75, v75
    v_mfma_f32_32x32x16_bf16 v[32:47], v[124:127], v[116:119], v[32:47]
    v_exp_f32 v76, v76
    v_exp_f32 v77, v77
    v_exp_f32 v78, v78
    v_smfmac_f32_32x32x32_bf16 v[96:111], v[136:139], v[64:71], v14
    s_waitcnt lgkmcnt(0)
    v_exp_f32 v79, v79
    v_exp_f32 v16, v16
    v_exp_f32 v17, v17
    v_exp_f32 v18, v18
    v_smfmac_f32_32x32x32_bf16 v[96:111], v[144:147], v[72:79], v14
    ds_read_b64_tr_b16 v[144:145], v10 offset:20992
    ds_read_b64_tr_b16 v[146:147], v11 offset:20992
    v_exp_f32 v19, v19
    v_exp_f32 v20, v20
    v_exp_f32 v21, v21
    v_exp_f32 v22, v22
    v_mfma_f32_32x32x4_2b_bf16 v[48:79], v[122:123], v[120:121], 0 cbsz:1 abid:1
    v_exp_f32 v23, v23
    v_exp_f32 v24, v24
    v_exp_f32 v25, v25
    v_exp_f32 v26, v26
    v_exp_f32 v27, v27
    v_exp_f32 v28, v28
    v_exp_f32 v29, v29
    v_exp_f32 v30, v30
    v_exp_f32 v31, v31
    v_smfmac_f32_32x32x32_bf16 v[80:95], v[132:135], v[16:23], v14
    v_exp_f32 v32, v32
    v_exp_f32 v33, v33
    v_exp_f32 v34, v34
    v_smfmac_f32_32x32x32_bf16 v[80:95], v[140:143], v[24:31], v14
    ds_read_b128 v[124:127], v1 offset:49152
    ds_read_b32 v122, v3 offset:22528
    v_exp_f32 v35, v35
    v_exp_f32 v36, v36
    v_exp_f32 v37, v37
    v_exp_f32 v38, v38
    v_exp_f32 v39, v39
    v_mfma_f32_32x32x16_bf16 v[48:63], v[128:131], v[112:115], v[48:63]
    ds_read_b64_tr_b16 v[136:137], v8 offset:20992
    ds_read_b64_tr_b16 v[138:139], v9 offset:20992
    v_exp_f32 v40, v40
    v_exp_f32 v41, v41
    v_exp_f32 v42, v42
    v_exp_f32 v43, v43
    v_mfma_f32_32x32x16_bf16 v[64:79], v[128:131], v[116:119], v[64:79]
    v_exp_f32 v44, v44
    v_exp_f32 v45, v45
    v_exp_f32 v46, v46
    v_smfmac_f32_32x32x32_bf16 v[96:111], v[132:135], v[32:39], v14
    s_waitcnt lgkmcnt(0)
    v_exp_f32 v47, v47
    v_exp_f32 v48, v48
    v_exp_f32 v49, v49
    v_exp_f32 v50, v50
    v_smfmac_f32_32x32x32_bf16 v[96:111], v[140:143], v[40:47], v14
    ds_read_b64_tr_b16 v[140:141], v10 offset:22528
    ds_read_b64_tr_b16 v[142:143], v11 offset:22528
    v_exp_f32 v51, v51
    v_exp_f32 v52, v52
    v_exp_f32 v53, v53
    v_exp_f32 v54, v54
    v_mfma_f32_32x32x4_2b_bf16 v[16:47], v[122:123], v[120:121], 0 cbsz:1 abid:0
    v_exp_f32 v55, v55
    v_exp_f32 v56, v56
    v_exp_f32 v57, v57
    v_exp_f32 v58, v58
    v_exp_f32 v59, v59
    v_exp_f32 v60, v60
    v_exp_f32 v61, v61
    v_exp_f32 v62, v62
    v_exp_f32 v63, v63
    v_smfmac_f32_32x32x32_bf16 v[80:95], v[136:139], v[48:55], v14
    v_exp_f32 v64, v64
    v_exp_f32 v65, v65
    v_exp_f32 v66, v66
    v_smfmac_f32_32x32x32_bf16 v[80:95], v[144:147], v[56:63], v14
    ds_read_b128 v[128:131], v1 offset:50176
    v_exp_f32 v67, v67
    v_exp_f32 v68, v68
    v_exp_f32 v69, v69
    v_exp_f32 v70, v70
    v_exp_f32 v71, v71
    v_mfma_f32_32x32x16_bf16 v[16:31], v[124:127], v[112:115], v[16:31]
    ds_read_b64_tr_b16 v[132:133], v8 offset:22528
    ds_read_b64_tr_b16 v[134:135], v9 offset:22528
    v_exp_f32 v72, v72
    v_exp_f32 v73, v73
    v_exp_f32 v74, v74
    v_exp_f32 v75, v75
    v_mfma_f32_32x32x16_bf16 v[32:47], v[124:127], v[116:119], v[32:47]
    v_exp_f32 v76, v76
    v_exp_f32 v77, v77
    v_exp_f32 v78, v78
    v_smfmac_f32_32x32x32_bf16 v[96:111], v[136:139], v[64:71], v14
    s_waitcnt lgkmcnt(0)
    v_exp_f32 v79, v79
    v_exp_f32 v16, v16
    v_exp_f32 v17, v17
    v_exp_f32 v18, v18
    v_smfmac_f32_32x32x32_bf16 v[96:111], v[144:147], v[72:79], v14
    ds_read_b64_tr_b16 v[144:145], v10 offset:23808
    ds_read_b64_tr_b16 v[146:147], v11 offset:23808
    v_exp_f32 v19, v19
    v_exp_f32 v20, v20
    v_exp_f32 v21, v21
    v_exp_f32 v22, v22
    v_mfma_f32_32x32x4_2b_bf16 v[48:79], v[122:123], v[120:121], 0 cbsz:1 abid:1
    v_exp_f32 v23, v23
    v_exp_f32 v24, v24
    v_exp_f32 v25, v25
    v_exp_f32 v26, v26
    v_exp_f32 v27, v27
    v_exp_f32 v28, v28
    v_exp_f32 v29, v29
    v_exp_f32 v30, v30
    v_exp_f32 v31, v31
    v_smfmac_f32_32x32x32_bf16 v[80:95], v[132:135], v[16:23], v14
    v_exp_f32 v32, v32
    v_exp_f32 v33, v33
    v_exp_f32 v34, v34
    v_smfmac_f32_32x32x32_bf16 v[80:95], v[140:143], v[24:31], v14
    ds_read_b128 v[124:127], v1 offset:51200
    ds_read_b32 v122, v3 offset:25344
    v_exp_f32 v35, v35
    v_exp_f32 v36, v36
    v_exp_f32 v37, v37
    v_exp_f32 v38, v38
    v_exp_f32 v39, v39
    v_mfma_f32_32x32x16_bf16 v[48:63], v[128:131], v[112:115], v[48:63]
    ds_read_b64_tr_b16 v[136:137], v8 offset:23808
    ds_read_b64_tr_b16 v[138:139], v9 offset:23808
    v_exp_f32 v40, v40
    v_exp_f32 v41, v41
    v_exp_f32 v42, v42
    v_exp_f32 v43, v43
    v_mfma_f32_32x32x16_bf16 v[64:79], v[128:131], v[116:119], v[64:79]
    v_exp_f32 v44, v44
    v_exp_f32 v45, v45
    v_exp_f32 v46, v46
    v_smfmac_f32_32x32x32_bf16 v[96:111], v[132:135], v[32:39], v14
    s_waitcnt lgkmcnt(0)
    v_exp_f32 v47, v47
    v_exp_f32 v48, v48
    v_exp_f32 v49, v49
    v_exp_f32 v50, v50
    v_smfmac_f32_32x32x32_bf16 v[96:111], v[140:143], v[40:47], v14
    ds_read_b64_tr_b16 v[140:141], v10 offset:25344
    ds_read_b64_tr_b16 v[142:143], v11 offset:25344
    v_exp_f32 v51, v51
    v_exp_f32 v52, v52
    v_exp_f32 v53, v53
    v_exp_f32 v54, v54
    v_mfma_f32_32x32x4_2b_bf16 v[16:47], v[122:123], v[120:121], 0 cbsz:1 abid:0
    v_exp_f32 v55, v55
    v_exp_f32 v56, v56
    v_exp_f32 v57, v57
    v_exp_f32 v58, v58
    v_exp_f32 v59, v59
    v_exp_f32 v60, v60
    v_exp_f32 v61, v61
    v_exp_f32 v62, v62
    v_exp_f32 v63, v63
    v_smfmac_f32_32x32x32_bf16 v[80:95], v[136:139], v[48:55], v14
    v_exp_f32 v64, v64
    v_exp_f32 v65, v65
    v_exp_f32 v66, v66
    v_smfmac_f32_32x32x32_bf16 v[80:95], v[144:147], v[56:63], v14
    ds_read_b128 v[128:131], v1 offset:52224
    v_exp_f32 v67, v67
    v_exp_f32 v68, v68
    v_exp_f32 v69, v69
    v_exp_f32 v70, v70
    v_exp_f32 v71, v71
    v_mfma_f32_32x32x16_bf16 v[16:31], v[124:127], v[112:115], v[16:31]
    ds_read_b64_tr_b16 v[132:133], v8 offset:25344
    ds_read_b64_tr_b16 v[134:135], v9 offset:25344
    v_exp_f32 v72, v72
    v_exp_f32 v73, v73
    v_exp_f32 v74, v74
    v_exp_f32 v75, v75
    v_mfma_f32_32x32x16_bf16 v[32:47], v[124:127], v[116:119], v[32:47]
    v_exp_f32 v76, v76
    v_exp_f32 v77, v77
    v_exp_f32 v78, v78
    v_smfmac_f32_32x32x32_bf16 v[96:111], v[136:139], v[64:71], v14
    s_waitcnt lgkmcnt(0)
    v_exp_f32 v79, v79
    v_exp_f32 v16, v16
    v_exp_f32 v17, v17
    v_exp_f32 v18, v18
    v_smfmac_f32_32x32x32_bf16 v[96:111], v[144:147], v[72:79], v14
    ds_read_b64_tr_b16 v[144:145], v10 offset:26624
    ds_read_b64_tr_b16 v[146:147], v11 offset:26624
    v_exp_f32 v19, v19
    v_exp_f32 v20, v20
    v_exp_f32 v21, v21
    v_exp_f32 v22, v22
    v_mfma_f32_32x32x4_2b_bf16 v[48:79], v[122:123], v[120:121], 0 cbsz:1 abid:1
    v_exp_f32 v23, v23
    v_exp_f32 v24, v24
    v_exp_f32 v25, v25
    v_exp_f32 v26, v26
    v_exp_f32 v27, v27
    v_exp_f32 v28, v28
    v_exp_f32 v29, v29
    v_exp_f32 v30, v30
    v_exp_f32 v31, v31
    v_smfmac_f32_32x32x32_bf16 v[80:95], v[132:135], v[16:23], v14
    v_exp_f32 v32, v32
    v_exp_f32 v33, v33
    v_exp_f32 v34, v34
    v_smfmac_f32_32x32x32_bf16 v[80:95], v[140:143], v[24:31], v14
    ds_read_b128 v[124:127], v1 offset:53248
    ds_read_b32 v122, v3 offset:28160
    v_exp_f32 v35, v35
    v_exp_f32 v36, v36
    v_exp_f32 v37, v37
    v_exp_f32 v38, v38
    v_exp_f32 v39, v39
    v_mfma_f32_32x32x16_bf16 v[48:63], v[128:131], v[112:115], v[48:63]
    ds_read_b64_tr_b16 v[136:137], v8 offset:26624
    ds_read_b64_tr_b16 v[138:139], v9 offset:26624
    v_exp_f32 v40, v40
    v_exp_f32 v41, v41
    v_exp_f32 v42, v42
    v_exp_f32 v43, v43
    v_mfma_f32_32x32x16_bf16 v[64:79], v[128:131], v[116:119], v[64:79]
    v_exp_f32 v44, v44
    v_exp_f32 v45, v45
    v_exp_f32 v46, v46
    v_smfmac_f32_32x32x32_bf16 v[96:111], v[132:135], v[32:39], v14
    s_waitcnt lgkmcnt(0)
    v_exp_f32 v47, v47
    v_exp_f32 v48, v48
    v_exp_f32 v49, v49
    v_exp_f32 v50, v50
    v_smfmac_f32_32x32x32_bf16 v[96:111], v[140:143], v[40:47], v14
    ds_read_b64_tr_b16 v[140:141], v10 offset:28160
    ds_read_b64_tr_b16 v[142:143], v11 offset:28160
    v_exp_f32 v51, v51
    v_exp_f32 v52, v52
    v_exp_f32 v53, v53
    v_exp_f32 v54, v54
    v_mfma_f32_32x32x4_2b_bf16 v[16:47], v[122:123], v[120:121], 0 cbsz:1 abid:0
    v_exp_f32 v55, v55
    v_exp_f32 v56, v56
    v_exp_f32 v57, v57
    v_exp_f32 v58, v58
    v_exp_f32 v59, v59
    v_exp_f32 v60, v60
    v_exp_f32 v61, v61
    v_exp_f32 v62, v62
    v_exp_f32 v63, v63
    v_smfmac_f32_32x32x32_bf16 v[80:95], v[136:139], v[48:55], v14
    v_exp_f32 v64, v64
    v_exp_f32 v65, v65
    v_exp_f32 v66, v66
    v_smfmac_f32_32x32x32_bf16 v[80:95], v[144:147], v[56:63], v14
    ds_read_b128 v[128:131], v1 offset:54272
    v_exp_f32 v67, v67
    v_exp_f32 v68, v68
    v_exp_f32 v69, v69
    v_exp_f32 v70, v70
    v_exp_f32 v71, v71
    v_mfma_f32_32x32x16_bf16 v[16:31], v[124:127], v[112:115], v[16:31]
    ds_read_b64_tr_b16 v[132:133], v8 offset:28160
    ds_read_b64_tr_b16 v[134:135], v9 offset:28160
    v_exp_f32 v72, v72
    v_exp_f32 v73, v73
    v_exp_f32 v74, v74
    v_exp_f32 v75, v75
    v_mfma_f32_32x32x16_bf16 v[32:47], v[124:127], v[116:119], v[32:47]
    v_exp_f32 v76, v76
    v_exp_f32 v77, v77
    v_exp_f32 v78, v78
    v_smfmac_f32_32x32x32_bf16 v[96:111], v[136:139], v[64:71], v14
    s_waitcnt lgkmcnt(0)
    v_exp_f32 v79, v79
    v_exp_f32 v16, v16
    v_exp_f32 v17, v17
    v_exp_f32 v18, v18
    v_smfmac_f32_32x32x32_bf16 v[96:111], v[144:147], v[72:79], v14
    ds_read_b64_tr_b16 v[144:145], v10 offset:29440
    ds_read_b64_tr_b16 v[146:147], v11 offset:29440
    v_exp_f32 v19, v19
    v_exp_f32 v20, v20
    v_exp_f32 v21, v21
    v_exp_f32 v22, v22
    v_mfma_f32_32x32x4_2b_bf16 v[48:79], v[122:123], v[120:121], 0 cbsz:1 abid:1
    v_exp_f32 v23, v23
    v_exp_f32 v24, v24
    v_exp_f32 v25, v25
    v_exp_f32 v26, v26
    v_exp_f32 v27, v27
    v_exp_f32 v28, v28
    v_exp_f32 v29, v29
    v_exp_f32 v30, v30
    v_exp_f32 v31, v31
    v_smfmac_f32_32x32x32_bf16 v[80:95], v[132:135], v[16:23], v14
    v_exp_f32 v32, v32
    v_exp_f32 v33, v33
    v_exp_f32 v34, v34
    v_smfmac_f32_32x32x32_bf16 v[80:95], v[140:143], v[24:31], v14
    ds_read_b128 v[124:127], v1 offset:55296
    ds_read_b32 v122, v3 offset:30976
    v_exp_f32 v35, v35
    v_exp_f32 v36, v36
    v_exp_f32 v37, v37
    v_exp_f32 v38, v38
    v_exp_f32 v39, v39
    v_mfma_f32_32x32x16_bf16 v[48:63], v[128:131], v[112:115], v[48:63]
    ds_read_b64_tr_b16 v[136:137], v8 offset:29440
    ds_read_b64_tr_b16 v[138:139], v9 offset:29440
    v_exp_f32 v40, v40
    v_exp_f32 v41, v41
    v_exp_f32 v42, v42
    v_exp_f32 v43, v43
    v_mfma_f32_32x32x16_bf16 v[64:79], v[128:131], v[116:119], v[64:79]
    v_exp_f32 v44, v44
    v_exp_f32 v45, v45
    v_exp_f32 v46, v46
    v_smfmac_f32_32x32x32_bf16 v[96:111], v[132:135], v[32:39], v14
    s_waitcnt lgkmcnt(0)
    v_exp_f32 v47, v47
    v_exp_f32 v48, v48
    v_exp_f32 v49, v49
    v_exp_f32 v50, v50
    v_smfmac_f32_32x32x32_bf16 v[96:111], v[140:143], v[40:47], v14
    ds_read_b64_tr_b16 v[140:141], v10 offset:30976
    ds_read_b64_tr_b16 v[142:143], v11 offset:30976
    v_exp_f32 v51, v51
    v_exp_f32 v52, v52
    v_exp_f32 v53, v53
    v_exp_f32 v54, v54
    v_mfma_f32_32x32x4_2b_bf16 v[16:47], v[122:123], v[120:121], 0 cbsz:1 abid:0
    v_exp_f32 v55, v55
    v_exp_f32 v56, v56
    v_exp_f32 v57, v57
    v_exp_f32 v58, v58
    v_exp_f32 v59, v59
    v_exp_f32 v60, v60
    v_exp_f32 v61, v61
    v_exp_f32 v62, v62
    v_exp_f32 v63, v63
    v_smfmac_f32_32x32x32_bf16 v[80:95], v[136:139], v[48:55], v14
    v_exp_f32 v64, v64
    v_exp_f32 v65, v65
    v_exp_f32 v66, v66
    v_smfmac_f32_32x32x32_bf16 v[80:95], v[144:147], v[56:63], v14
    ds_read_b128 v[128:131], v1 offset:56320
    v_exp_f32 v67, v67
    v_exp_f32 v68, v68
    v_exp_f32 v69, v69
    v_exp_f32 v70, v70
    v_exp_f32 v71, v71
    v_mfma_f32_32x32x16_bf16 v[16:31], v[124:127], v[112:115], v[16:31]
    ds_read_b64_tr_b16 v[132:133], v8 offset:30976
    ds_read_b64_tr_b16 v[134:135], v9 offset:30976
    v_exp_f32 v72, v72
    v_exp_f32 v73, v73
    v_exp_f32 v74, v74
    v_exp_f32 v75, v75
    v_mfma_f32_32x32x16_bf16 v[32:47], v[124:127], v[116:119], v[32:47]
    v_exp_f32 v76, v76
    v_exp_f32 v77, v77
    v_exp_f32 v78, v78
    v_smfmac_f32_32x32x32_bf16 v[96:111], v[136:139], v[64:71], v14
    s_waitcnt lgkmcnt(0)
    v_exp_f32 v79, v79
    v_exp_f32 v16, v16
    v_exp_f32 v17, v17
    v_exp_f32 v18, v18
    v_smfmac_f32_32x32x32_bf16 v[96:111], v[144:147], v[72:79], v14
    s_setprio 2
    ds_read_b64_tr_b16 v[144:145], v10 offset:32256
    ds_read_b64_tr_b16 v[146:147], v11 offset:32256
    v_exp_f32 v19, v19
    v_exp_f32 v20, v20
    v_exp_f32 v21, v21
    v_exp_f32 v22, v22
    v_mfma_f32_32x32x4_2b_bf16 v[48:79], v[122:123], v[120:121], 0 cbsz:1 abid:1
    v_exp_f32 v23, v23
    v_exp_f32 v24, v24
    v_exp_f32 v25, v25
    v_exp_f32 v26, v26
    v_exp_f32 v27, v27
    v_exp_f32 v28, v28
    v_exp_f32 v29, v29
    v_exp_f32 v30, v30
    v_exp_f32 v31, v31
    v_smfmac_f32_32x32x32_bf16 v[80:95], v[132:135], v[16:23], v14
    v_exp_f32 v32, v32
    v_exp_f32 v33, v33
    v_exp_f32 v34, v34
    v_smfmac_f32_32x32x32_bf16 v[80:95], v[140:143], v[24:31], v14
    ds_read_b128 v[124:127], v1 offset:57344
    ds_read_b32 v122, v3 offset:33792
    v_exp_f32 v35, v35
    v_exp_f32 v36, v36
    v_exp_f32 v37, v37
    v_exp_f32 v38, v38
    v_exp_f32 v39, v39
    v_mfma_f32_32x32x16_bf16 v[48:63], v[128:131], v[112:115], v[48:63]
    ds_read_b64_tr_b16 v[136:137], v8 offset:32256
    ds_read_b64_tr_b16 v[138:139], v9 offset:32256
    v_exp_f32 v40, v40
    v_exp_f32 v41, v41
    v_exp_f32 v42, v42
    v_exp_f32 v43, v43
    v_mfma_f32_32x32x16_bf16 v[64:79], v[128:131], v[116:119], v[64:79]
    v_exp_f32 v44, v44
    v_exp_f32 v45, v45
    v_exp_f32 v46, v46
    v_smfmac_f32_32x32x32_bf16 v[96:111], v[132:135], v[32:39], v14
    s_waitcnt lgkmcnt(0)
    v_exp_f32 v47, v47
    v_exp_f32 v48, v48
    v_exp_f32 v49, v49
    v_exp_f32 v50, v50
    v_smfmac_f32_32x32x32_bf16 v[96:111], v[140:143], v[40:47], v14
    ds_read_b64_tr_b16 v[140:141], v10 offset:33792
    ds_read_b64_tr_b16 v[142:143], v11 offset:33792
    v_exp_f32 v51, v51
    v_exp_f32 v52, v52
    v_exp_f32 v53, v53
    v_exp_f32 v54, v54
    v_mfma_f32_32x32x4_2b_bf16 v[16:47], v[122:123], v[120:121], 0 cbsz:1 abid:0
    v_exp_f32 v55, v55
    v_exp_f32 v56, v56
    v_exp_f32 v57, v57
    v_exp_f32 v58, v58
    v_exp_f32 v59, v59
    v_exp_f32 v60, v60
    v_exp_f32 v61, v61
    v_exp_f32 v62, v62
    v_exp_f32 v63, v63
    v_smfmac_f32_32x32x32_bf16 v[80:95], v[136:139], v[48:55], v14
    v_exp_f32 v64, v64
    v_exp_f32 v65, v65
    v_exp_f32 v66, v66
    v_smfmac_f32_32x32x32_bf16 v[80:95], v[144:147], v[56:63], v14
    ds_read_b128 v[128:131], v1 offset:58368
    v_exp_f32 v67, v67
    v_exp_f32 v68, v68
    v_exp_f32 v69, v69
    v_exp_f32 v70, v70
    v_exp_f32 v71, v71
    v_mfma_f32_32x32x16_bf16 v[16:31], v[124:127], v[112:115], v[16:31]
    ds_read_b64_tr_b16 v[132:133], v8 offset:33792
    ds_read_b64_tr_b16 v[134:135], v9 offset:33792
    v_exp_f32 v72, v72
    v_exp_f32 v73, v73
    v_exp_f32 v74, v74
    v_exp_f32 v75, v75
    v_mfma_f32_32x32x16_bf16 v[32:47], v[124:127], v[116:119], v[32:47]
    v_exp_f32 v76, v76
    v_exp_f32 v77, v77
    v_exp_f32 v78, v78
    v_smfmac_f32_32x32x32_bf16 v[96:111], v[136:139], v[64:71], v14
    s_waitcnt lgkmcnt(0)
    v_exp_f32 v79, v79
    v_exp_f32 v16, v16
    v_exp_f32 v17, v17
    v_exp_f32 v18, v18
    v_smfmac_f32_32x32x32_bf16 v[96:111], v[144:147], v[72:79], v14
    ds_read_b64_tr_b16 v[144:145], v10 offset:35072
    ds_read_b64_tr_b16 v[146:147], v11 offset:35072
    v_exp_f32 v19, v19
    v_exp_f32 v20, v20
    v_exp_f32 v21, v21
    v_exp_f32 v22, v22
    v_mfma_f32_32x32x4_2b_bf16 v[48:79], v[122:123], v[120:121], 0 cbsz:1 abid:1
    v_exp_f32 v23, v23
    v_exp_f32 v24, v24
    v_exp_f32 v25, v25
    v_exp_f32 v26, v26
    v_exp_f32 v27, v27
    v_exp_f32 v28, v28
    v_exp_f32 v29, v29
    v_exp_f32 v30, v30
    v_exp_f32 v31, v31
    v_smfmac_f32_32x32x32_bf16 v[80:95], v[132:135], v[16:23], v14
    v_exp_f32 v32, v32
    v_exp_f32 v33, v33
    v_exp_f32 v34, v34
    v_smfmac_f32_32x32x32_bf16 v[80:95], v[140:143], v[24:31], v14
    ds_read_b128 v[124:127], v1 offset:59392
    ds_read_b32 v122, v3 offset:36608
    v_exp_f32 v35, v35
    v_exp_f32 v36, v36
    v_exp_f32 v37, v37
    v_exp_f32 v38, v38
    v_exp_f32 v39, v39
    v_mfma_f32_32x32x16_bf16 v[48:63], v[128:131], v[112:115], v[48:63]
    ds_read_b64_tr_b16 v[136:137], v8 offset:35072
    ds_read_b64_tr_b16 v[138:139], v9 offset:35072
    v_exp_f32 v40, v40
    v_exp_f32 v41, v41
    v_exp_f32 v42, v42
    v_exp_f32 v43, v43
    v_mfma_f32_32x32x16_bf16 v[64:79], v[128:131], v[116:119], v[64:79]
    v_exp_f32 v44, v44
    v_exp_f32 v45, v45
    v_exp_f32 v46, v46
    v_smfmac_f32_32x32x32_bf16 v[96:111], v[132:135], v[32:39], v14
    s_waitcnt lgkmcnt(0)
    v_exp_f32 v47, v47
    v_exp_f32 v48, v48
    v_exp_f32 v49, v49
    v_exp_f32 v50, v50
    v_smfmac_f32_32x32x32_bf16 v[96:111], v[140:143], v[40:47], v14
    ds_read_b64_tr_b16 v[140:141], v10 offset:36608
    ds_read_b64_tr_b16 v[142:143], v11 offset:36608
    v_exp_f32 v51, v51
    v_exp_f32 v52, v52
    v_exp_f32 v53, v53
    v_exp_f32 v54, v54
    v_mfma_f32_32x32x4_2b_bf16 v[16:47], v[122:123], v[120:121], 0 cbsz:1 abid:0
    v_exp_f32 v55, v55
    v_exp_f32 v56, v56
    v_exp_f32 v57, v57
    v_exp_f32 v58, v58
    v_exp_f32 v59, v59
    v_exp_f32 v60, v60
    v_exp_f32 v61, v61
    v_exp_f32 v62, v62
    v_exp_f32 v63, v63
    v_smfmac_f32_32x32x32_bf16 v[80:95], v[136:139], v[48:55], v14
    v_exp_f32 v64, v64
    v_exp_f32 v65, v65
    v_exp_f32 v66, v66
    v_smfmac_f32_32x32x32_bf16 v[80:95], v[144:147], v[56:63], v14
    ds_read_b128 v[128:131], v1 offset:60416
    v_exp_f32 v67, v67
    v_exp_f32 v68, v68
    v_exp_f32 v69, v69
    v_exp_f32 v70, v70
    v_exp_f32 v71, v71
    v_mfma_f32_32x32x16_bf16 v[16:31], v[124:127], v[112:115], v[16:31]
    ds_read_b64_tr_b16 v[132:133], v8 offset:36608
    ds_read_b64_tr_b16 v[134:135], v9 offset:36608
    v_exp_f32 v72, v72
    v_exp_f32 v73, v73
    v_exp_f32 v74, v74
    v_exp_f32 v75, v75
    v_mfma_f32_32x32x16_bf16 v[32:47], v[124:127], v[116:119], v[32:47]
    v_exp_f32 v76, v76
    v_exp_f32 v77, v77
    v_exp_f32 v78, v78
    v_smfmac_f32_32x32x32_bf16 v[96:111], v[136:139], v[64:71], v14
    s_waitcnt lgkmcnt(0)
    v_exp_f32 v79, v79
    v_exp_f32 v16, v16
    v_exp_f32 v17, v17
    v_exp_f32 v18, v18
    v_smfmac_f32_32x32x32_bf16 v[96:111], v[144:147], v[72:79], v14
    ds_read_b64_tr_b16 v[144:145], v10 offset:37888
    ds_read_b64_tr_b16 v[146:147], v11 offset:37888
    v_exp_f32 v19, v19
    v_exp_f32 v20, v20
    v_exp_f32 v21, v21
    v_exp_f32 v22, v22
    v_mfma_f32_32x32x4_2b_bf16 v[48:79], v[122:123], v[120:121], 0 cbsz:1 abid:1
L_t4:
    s_cbranch_execz L_ret
    v_exp_f32 v23, v23
    v_exp_f32 v24, v24
    v_exp_f32 v25, v25
    v_exp_f32 v26, v26
    v_exp_f32 v27, v27
    v_exp_f32 v28, v28
    v_exp_f32 v29, v29
    v_exp_f32 v30, v30
    v_exp_f32 v31, v31
    v_smfmac_f32_32x32x32_bf16 v[80:95], v[132:135], v[16:23], v14
    v_exp_f32 v32, v32
    v_exp_f32 v33, v33
    v_exp_f32 v34, v34
    v_smfmac_f32_32x32x32_bf16 v[80:95], v[140:143], v[24:31], v14
    ds_read_b128 v[124:127], v1 offset:61440
    ds_read_b32 v122, v3 offset:39424
    v_exp_f32 v35, v35
    v_exp_f32 v36, v36
    v_exp_f32 v37, v37
    v_exp_f32 v38, v38
    v_exp_f32 v39, v39
    v_mfma_f32_32x32x16_bf16 v[48:63], v[128:131], v[112:115], v[48:63]
    ds_read_b64_tr_b16 v[136:137], v8 offset:37888
    ds_read_b64_tr_b16 v[138:139], v9 offset:37888
    v_exp_f32 v40, v40
    v_exp_f32 v41, v41
    v_exp_f32 v42, v42
    v_exp_f32 v43, v43
    v_mfma_f32_32x32x16_bf16 v[64:79], v[128:131], v[116:119], v[64:79]
    v_exp_f32 v44, v44
    v_exp_f32 v45, v45
    v_exp_f32 v46, v46
    v_smfmac_f32_32x32x32_bf16 v[96:111], v[132:135], v[32:39], v14
    s_waitcnt lgkmcnt(0)
    v_exp_f32 v47, v47
    v_exp_f32 v48, v48
    v_exp_f32 v49, v49
    v_exp_f32 v50, v50
    v_smfmac_f32_32x32x32_bf16 v[96:111], v[140:143], v[40:47], v14
    ds_read_b64_tr_b16 v[140:141], v10 offset:39424
    ds_read_b64_tr_b16 v[142:143], v11 offset:39424
    v_exp_f32 v51, v51
    v_exp_f32 v52, v52
    v_exp_f32 v53, v53
    v_exp_f32 v54, v54
    v_mfma_f32_32x32x4_2b_bf16 v[16:47], v[122:123], v[120:121], 0 cbsz:1 abid:0
    v_exp_f32 v55, v55
    v_exp_f32 v56, v56
    v_exp_f32 v57, v57
    v_exp_f32 v58, v58
    v_exp_f32 v59, v59
    v_exp_f32 v60, v60
    v_exp_f32 v61, v61
    v_exp_f32 v62, v62
    v_exp_f32 v63, v63
    v_smfmac_f32_32x32x32_bf16 v[80:95], v[136:139], v[48:55], v14
    v_exp_f32 v64, v64
    v_exp_f32 v65, v65
    v_exp_f32 v66, v66
    v_smfmac_f32_32x32x32_bf16 v[80:95], v[144:147], v[56:63], v14
    ds_read_b128 v[128:131], v1 offset:62464
    v_exp_f32 v67, v67
    v_exp_f32 v68, v68
    v_exp_f32 v69, v69
    v_exp_f32 v70, v70
    v_exp_f32 v71, v71
    v_mfma_f32_32x32x16_bf16 v[16:31], v[124:127], v[112:115], v[16:31]
    ds_read_b64_tr_b16 v[132:133], v8 offset:39424
    ds_read_b64_tr_b16 v[134:135], v9 offset:39424
    v_exp_f32 v72, v72
    v_exp_f32 v73, v73
    v_exp_f32 v74, v74
    v_exp_f32 v75, v75
    v_mfma_f32_32x32x16_bf16 v[32:47], v[124:127], v[116:119], v[32:47]
    v_exp_f32 v76, v76
    v_exp_f32 v77, v77
    v_exp_f32 v78, v78
    v_smfmac_f32_32x32x32_bf16 v[96:111], v[136:139], v[64:71], v14
    s_waitcnt lgkmcnt(0)
    v_exp_f32 v79, v79
    v_exp_f32 v16, v16
    v_exp_f32 v17, v17
    v_exp_f32 v18, v18
    v_smfmac_f32_32x32x32_bf16 v[96:111], v[144:147], v[72:79], v14
    s_setprio 1
    ds_read_b64_tr_b16 v[144:145], v10 offset:40704
    ds_read_b64_tr_b16 v[146:147], v11 offset:40704
    v_exp_f32 v19, v19
    v_exp_f32 v20, v20
    v_exp_f32 v21, v21
    v_exp_f32 v22, v22
    v_mfma_f32_32x32x4_2b_bf16 v[48:79], v[122:123], v[120:121], 0 cbsz:1 abid:1
    v_exp_f32 v23, v23
    v_exp_f32 v24, v24
    v_exp_f32 v25, v25
    v_exp_f32 v26, v26
    v_exp_f32 v27, v27
    v_exp_f32 v28, v28
    v_exp_f32 v29, v29
    v_exp_f32 v30, v30
    v_exp_f32 v31, v31
    v_smfmac_f32_32x32x32_bf16 v[80:95], v[132:135], v[16:23], v14
    v_exp_f32 v32, v32
    v_exp_f32 v33, v33
    v_exp_f32 v34, v34
    v_smfmac_f32_32x32x32_bf16 v[80:95], v[140:143], v[24:31], v14
    ds_read_b128 v[124:127], v1 offset:63488
    ds_read_b32 v122, v3 offset:42240
    v_exp_f32 v35, v35
    v_exp_f32 v36, v36
    v_exp_f32 v37, v37
    v_exp_f32 v38, v38
    v_exp_f32 v39, v39
    v_mfma_f32_32x32x16_bf16 v[48:63], v[128:131], v[112:115], v[48:63]
    ds_read_b64_tr_b16 v[136:137], v8 offset:40704
    ds_read_b64_tr_b16 v[138:139], v9 offset:40704
    v_exp_f32 v40, v40
    v_exp_f32 v41, v41
    v_exp_f32 v42, v42
    v_exp_f32 v43, v43
    v_mfma_f32_32x32x16_bf16 v[64:79], v[128:131], v[116:119], v[64:79]
    v_exp_f32 v44, v44
    v_exp_f32 v45, v45
    v_exp_f32 v46, v46
    v_smfmac_f32_32x32x32_bf16 v[96:111], v[132:135], v[32:39], v14
    s_waitcnt lgkmcnt(0)
    v_exp_f32 v47, v47
    v_exp_f32 v48, v48
    v_exp_f32 v49, v49
    v_exp_f32 v50, v50
    v_smfmac_f32_32x32x32_bf16 v[96:111], v[140:143], v[40:47], v14
    ds_read_b64_tr_b16 v[140:141], v10 offset:42240
    ds_read_b64_tr_b16 v[142:143], v11 offset:42240
    v_exp_f32 v51, v51
    v_exp_f32 v52, v52
    v_exp_f32 v53, v53
    v_exp_f32 v54, v54
    v_mfma_f32_32x32x4_2b_bf16 v[16:47], v[122:123], v[120:121], 0 cbsz:1 abid:0
    v_exp_f32 v55, v55
    v_exp_f32 v56, v56
    v_exp_f32 v57, v57
    v_exp_f32 v58, v58
    v_exp_f32 v59, v59
    v_exp_f32 v60, v60
    v_exp_f32 v61, v61
    v_exp_f32 v62, v62
    v_exp_f32 v63, v63
    v_smfmac_f32_32x32x32_bf16 v[80:95], v[136:139], v[48:55], v14
    v_exp_f32 v64, v64
    v_exp_f32 v65, v65
    v_exp_f32 v66, v66
    v_smfmac_f32_32x32x32_bf16 v[80:95], v[144:147], v[56:63], v14
    s_setprio 0
    ds_read_b128 v[128:131], v1 offset:64512
    v_exp_f32 v67, v67
    v_exp_f32 v68, v68
    v_exp_f32 v69, v69
    v_exp_f32 v70, v70
    v_exp_f32 v71, v71
    v_mfma_f32_32x32x16_bf16 v[16:31], v[124:127], v[112:115], v[16:31]
    ds_read_b64_tr_b16 v[132:133], v8 offset:42240
    ds_read_b64_tr_b16 v[134:135], v9 offset:42240
    v_exp_f32 v72, v72
    v_exp_f32 v73, v73
    v_exp_f32 v74, v74
    v_exp_f32 v75, v75
    v_mfma_f32_32x32x16_bf16 v[32:47], v[124:127], v[116:119], v[32:47]
    v_exp_f32 v76, v76
    v_exp_f32 v77, v77
    v_exp_f32 v78, v78
    v_smfmac_f32_32x32x32_bf16 v[96:111], v[136:139], v[64:71], v14
    s_waitcnt lgkmcnt(0)
    v_exp_f32 v79, v79
    v_exp_f32 v16, v16
    v_exp_f32 v17, v17
    v_exp_f32 v18, v18
    v_smfmac_f32_32x32x32_bf16 v[96:111], v[144:147], v[72:79], v14
    ds_read_b64_tr_b16 v[144:145], v10 offset:43520
    ds_read_b64_tr_b16 v[146:147], v11 offset:43520
    v_exp_f32 v19, v19
    v_exp_f32 v20, v20
    v_exp_f32 v21, v21
    v_exp_f32 v22, v22
    v_mfma_f32_32x32x4_2b_bf16 v[48:79], v[122:123], v[120:121], 0 cbsz:1 abid:1
    v_exp_f32 v23, v23
    v_exp_f32 v24, v24
    v_exp_f32 v25, v25
    v_exp_f32 v26, v26
    v_exp_f32 v27, v27
    v_exp_f32 v28, v28
    v_exp_f32 v29, v29
    v_exp_f32 v30, v30
    v_exp_f32 v31, v31
    v_smfmac_f32_32x32x32_bf16 v[80:95], v[132:135], v[16:23], v14
    v_exp_f32 v32, v32
    v_exp_f32 v33, v33
    v_exp_f32 v34, v34
    v_smfmac_f32_32x32x32_bf16 v[80:95], v[140:143], v[24:31], v14
    v_exp_f32 v35, v35
    v_exp_f32 v36, v36
    v_exp_f32 v37, v37
    v_exp_f32 v38, v38
    v_exp_f32 v39, v39
    v_mfma_f32_32x32x16_bf16 v[48:63], v[128:131], v[112:115], v[48:63]
    ds_read_b64_tr_b16 v[136:137], v8 offset:43520
    ds_read_b64_tr_b16 v[138:139], v9 offset:43520
    v_exp_f32 v40, v40
    v_exp_f32 v41, v41
    v_exp_f32 v42, v42
    v_exp_f32 v43, v43
    v_mfma_f32_32x32x16_bf16 v[64:79], v[128:131], v[116:119], v[64:79]
    v_exp_f32 v44, v44
    v_exp_f32 v45, v45
    v_exp_f32 v46, v46
    v_smfmac_f32_32x32x32_bf16 v[96:111], v[132:135], v[32:39], v14
    s_waitcnt lgkmcnt(0)
    v_exp_f32 v47, v47
    v_exp_f32 v48, v48
    v_exp_f32 v49, v49
    v_exp_f32 v50, v50
    v_smfmac_f32_32x32x32_bf16 v[96:111], v[140:143], v[40:47], v14
    v_exp_f32 v51, v51
    v_exp_f32 v52, v52
    v_exp_f32 v53, v53
    v_exp_f32 v54, v54
    v_exp_f32 v55, v55
    v_exp_f32 v56, v56
    v_exp_f32 v57, v57
    v_exp_f32 v58, v58
    v_exp_f32 v59, v59
    v_exp_f32 v60, v60
    v_exp_f32 v61, v61
    v_exp_f32 v62, v62
    v_exp_f32 v63, v63
    v_smfmac_f32_32x32x32_bf16 v[80:95], v[136:139], v[48:55], v14
    v_exp_f32 v64, v64
    v_exp_f32 v65, v65
    v_exp_f32 v66, v66
    v_smfmac_f32_32x32x32_bf16 v[80:95], v[144:147], v[56:63], v14
    v_exp_f32 v67, v67
    v_exp_f32 v68, v68
    v_exp_f32 v69, v69
    v_exp_f32 v70, v70
    v_exp_f32 v71, v71
    v_exp_f32 v72, v72
    v_exp_f32 v73, v73
    v_exp_f32 v74, v74
    v_exp_f32 v75, v75
    v_exp_f32 v76, v76
    v_exp_f32 v77, v77
    v_exp_f32 v78, v78
    v_smfmac_f32_32x32x32_bf16 v[96:111], v[136:139], v[64:71], v14
    v_exp_f32 v79, v79
    s_nop 1
    v_smfmac_f32_32x32x32_bf16 v[96:111], v[144:147], v[72:79], v14
L_epi:
    v_mov_b32 v162, v90
    s_nop 1
    v_permlane32_swap_b32 v90, v162
    s_nop 0
    v_rcp_f32 v162, v90
    s_nop 0
    v_pk_mul_f32 v[80:81], v[80:81], v[162:163] op_sel_hi:[1,0]
    v_pk_mul_f32 v[82:83], v[82:83], v[162:163] op_sel_hi:[1,0]
    v_pk_mul_f32 v[84:85], v[84:85], v[162:163] op_sel_hi:[1,0]
    v_pk_mul_f32 v[86:87], v[86:87], v[162:163] op_sel_hi:[1,0]
    v_pk_mul_f32 v[88:89], v[88:89], v[162:163] op_sel_hi:[1,0]
    v_cvt_pk_bf16_f32 v168, v80, v81
    v_cvt_pk_bf16_f32 v169, v82, v83
    ds_write2_b32 v180, v168, v169 offset0:0 offset1:1
    v_cvt_pk_bf16_f32 v170, v84, v85
    v_cvt_pk_bf16_f32 v171, v86, v87
    ds_write2_b32 v180, v170, v171 offset0:2 offset1:3
    v_cvt_pk_bf16_f32 v172, v88, v89
    ds_write_b32 v182, v172 offset:4
    ds_read_b128 v[16:19], v183 offset:0
    v_mov_b32 v164, v106
    s_nop 1
    v_permlane32_swap_b32 v106, v164
    s_nop 0
    v_rcp_f32 v164, v106
    s_nop 0
    v_pk_mul_f32 v[96:97], v[96:97], v[164:165] op_sel_hi:[1,0]
    v_pk_mul_f32 v[98:99], v[98:99], v[164:165] op_sel_hi:[1,0]
    v_pk_mul_f32 v[100:101], v[100:101], v[164:165] op_sel_hi:[1,0]
    v_pk_mul_f32 v[102:103], v[102:103], v[164:165] op_sel_hi:[1,0]
    v_pk_mul_f32 v[104:105], v[104:105], v[164:165] op_sel_hi:[1,0]
    v_cvt_pk_bf16_f32 v174, v96, v97
    v_cvt_pk_bf16_f32 v175, v98, v99
    s_waitcnt lgkmcnt(0)
    buffer_store_dwordx4 v[16:19], v1, s[24:27], 0 offen sc1
    ds_write2_b32 v181, v174, v175 offset0:0 offset1:1
    v_cvt_pk_bf16_f32 v176, v100, v101
    v_cvt_pk_bf16_f32 v177, v102, v103
    ds_write2_b32 v181, v176, v177 offset0:2 offset1:3
    v_cvt_pk_bf16_f32 v178, v104, v105
    ds_write_b32 v182, v178 offset:1156
    ds_read_b128 v[20:23], v183 offset:1024
    ds_read_b32 v24, v184
    s_waitcnt lgkmcnt(1)
    buffer_store_dwordx4 v[20:23], v1, s[24:27], 0 offen offset:1024 sc1
    s_waitcnt lgkmcnt(0)
    buffer_store_dword v24, v185, s[24:27], 0 offen offset:2048 sc1
    s_cmp_lg_u32 s37, 0
    s_cbranch_scc1 L_fin
    v_pk_mul_f32 v[166:167], v[80:81], 0 op_sel_hi:[1,0]
    v_pk_fma_f32 v[166:167], v[82:83], 0, v[166:167] op_sel_hi:[1,0,1]
    v_pk_fma_f32 v[166:167], v[84:85], 0, v[166:167] op_sel_hi:[1,0,1]
    v_pk_fma_f32 v[166:167], v[86:87], 0, v[166:167] op_sel_hi:[1,0,1]
    v_pk_fma_f32 v[166:167], v[88:89], 0, v[166:167] op_sel_hi:[1,0,1]
    v_pk_fma_f32 v[166:167], v[96:97], 0, v[166:167] op_sel_hi:[1,0,1]
    v_pk_fma_f32 v[166:167], v[98:99], 0, v[166:167] op_sel_hi:[1,0,1]
    v_pk_fma_f32 v[166:167], v[100:101], 0, v[166:167] op_sel_hi:[1,0,1]
    v_pk_fma_f32 v[166:167], v[102:103], 0, v[166:167] op_sel_hi:[1,0,1]
    v_pk_fma_f32 v[166:167], v[104:105], 0, v[166:167] op_sel_hi:[1,0,1]
    s_mov_b32 s3, 0x3f800000
    v_add_f32 v166, v166, v167
    s_mov_b32 s33, 0x7c800000
    v_add_f32 v166, v166, v90
    v_cmp_le_f32 s[8:9], s3, v106
    v_cmp_ge_f32 s[10:11], s33, v106
    v_cmp_le_f32 s[4:5], s3, v166
    v_cmp_ge_f32 s[6:7], s33, v166
    s_nop 3
    s_and_b64 s[4:5], s[4:5], s[6:7]
    s_and_b64 s[8:9], s[8:9], s[10:11]
    s_and_b64 s[4:5], s[4:5], s[8:9]
    s_cmp_eq_u64 s[4:5], -1
    s_cbranch_scc0 L_fallback
L_fin:
    s_endpgm
L_fallback:
    s_waitcnt vmcnt(0)
    s_mov_b32 s37, 1
    v_mov_b32 v121, 0
    v_mov_b32 v162, 0xff800000
    v_mov_b32 v163, 0xff800000
    v_mov_b32 v164, v156
    v_mov_b32 v165, v2
    s_mov_b32 s3, 0
L_fb1:
    ds_read_b32 v122, v165
    buffer_load_dwordx4 v[124:127], v164, s[16:19], 0 offen
    buffer_load_dwordx4 v[128:131], v164, s[16:19], 0 offen offset:1152
    s_waitcnt vmcnt(0) lgkmcnt(0)
    v_mfma_f32_32x32x4_2b_bf16 v[16:47], v[122:123], v[120:121], 0 cbsz:1 abid:0
    v_mfma_f32_32x32x4_2b_bf16 v[48:79], v[122:123], v[120:121], 0 cbsz:1 abid:1
    s_nop 15
    s_nop 3
    v_mfma_f32_32x32x16_bf16 v[16:31], v[124:127], v[112:115], v[16:31]
    v_mfma_f32_32x32x16_bf16 v[32:47], v[124:127], v[116:119], v[32:47]
    v_mfma_f32_32x32x16_bf16 v[48:63], v[128:131], v[112:115], v[48:63]
    v_mfma_f32_32x32x16_bf16 v[64:79], v[128:131], v[116:119], v[64:79]
    s_nop 15
    v_max3_f32 v162, v16, v17, v162
    v_max3_f32 v162, v18, v19, v162
    v_max3_f32 v162, v20, v21, v162
    v_max3_f32 v162, v22, v23, v162
    v_max3_f32 v162, v24, v25, v162
    v_max3_f32 v162, v26, v27, v162
    v_max3_f32 v162, v28, v29, v162
    v_max3_f32 v162, v30, v31, v162
    v_max3_f32 v163, v32, v33, v163
    v_max3_f32 v163, v34, v35, v163
    v_max3_f32 v163, v36, v37, v163
    v_max3_f32 v163, v38, v39, v163
    v_max3_f32 v163, v40, v41, v163
    v_max3_f32 v163, v42, v43, v163
    v_max3_f32 v163, v44, v45, v163
    v_max3_f32 v163, v46, v47, v163
    v_max3_f32 v162, v48, v49, v162
    v_max3_f32 v162, v50, v51, v162
    v_max3_f32 v162, v52, v53, v162
    v_max3_f32 v162, v54, v55, v162
    v_max3_f32 v162, v56, v57, v162
    v_max3_f32 v162, v58, v59, v162
    v_max3_f32 v162, v60, v61, v162
    v_max3_f32 v162, v62, v63, v162
    v_max3_f32 v163, v64, v65, v163
    v_max3_f32 v163, v66, v67, v163
    v_max3_f32 v163, v68, v69, v163
    v_max3_f32 v163, v70, v71, v163
    v_max3_f32 v163, v72, v73, v163
    v_max3_f32 v163, v74, v75, v163
    v_max3_f32 v163, v76, v77, v163
    v_max3_f32 v163, v78, v79, v163
    v_add_u32 v164, 2304, v164
    v_add_u32 v165, 2816, v165
    s_add_u32 s3, s3, 1
    s_cmp_lt_u32 s3, 32
    s_cbranch_scc1 L_fb1
    v_mov_b32 v164, v162
    s_nop 1
    v_permlane32_swap_b32 v164, v162
    s_nop 1
    v_max_f32 v162, v164, v162
    v_mov_b32 v164, v163
    s_nop 1
    v_permlane32_swap_b32 v164, v163
    s_nop 1
    v_max_f32 v163, v164, v163
    v_mov_b32 v164, v156
    v_mov_b32 v165, v2
    v_mov_b32 v166, v4
    v_mov_b32 v167, v5
    v_mov_b32 v168, v6
    v_mov_b32 v169, v7
    v_mov_b32 v80, 0
    v_mov_b32 v81, 0
    v_mov_b32 v82, 0
    v_mov_b32 v83, 0
    v_mov_b32 v84, 0
    v_mov_b32 v85, 0
    v_mov_b32 v86, 0
    v_mov_b32 v87, 0
    v_mov_b32 v88, 0
    v_mov_b32 v89, 0
    v_mov_b32 v90, 0
    v_mov_b32 v91, 0
    v_mov_b32 v92, 0
    v_mov_b32 v93, 0
    v_mov_b32 v94, 0
    v_mov_b32 v95, 0
    v_mov_b32 v96, 0
    v_mov_b32 v97, 0
    v_mov_b32 v98, 0
    v_mov_b32 v99, 0
    v_mov_b32 v100, 0
    v_mov_b32 v101, 0
    v_mov_b32 v102, 0
    v_mov_b32 v103, 0
    v_mov_b32 v104, 0
    v_mov_b32 v105, 0
    v_mov_b32 v106, 0
    v_mov_b32 v107, 0
    v_mov_b32 v108, 0
    v_mov_b32 v109, 0
    v_mov_b32 v110, 0
    v_mov_b32 v111, 0
    s_mov_b32 s3, 0
L_fb2:
    ds_read_b32 v122, v165
    buffer_load_dwordx4 v[124:127], v164, s[16:19], 0 offen
    buffer_load_dwordx4 v[128:131], v164, s[16:19], 0 offen offset:1152
    ds_read_b64_tr_b16 v[132:133], v166 offset:0
    ds_read_b64_tr_b16 v[134:135], v167 offset:0
    ds_read_b64_tr_b16 v[140:141], v168 offset:0
    ds_read_b64_tr_b16 v[142:143], v169 offset:0
    ds_read_b64_tr_b16 v[136:137], v166 offset:1280
    ds_read_b64_tr_b16 v[138:139], v167 offset:1280
    ds_read_b64_tr_b16 v[144:145], v168 offset:1280
    ds_read_b64_tr_b16 v[146:147], v169 offset:1280
    s_waitcnt vmcnt(0) lgkmcnt(0)
    v_mfma_f32_32x32x4_2b_bf16 v[16:47], v[122:123], v[120:121], 0 cbsz:1 abid:0
    v_mfma_f32_32x32x4_2b_bf16 v[48:79], v[122:123], v[120:121], 0 cbsz:1 abid:1
    s_nop 15
    s_nop 3
    v_mfma_f32_32x32x16_bf16 v[16:31], v[124:127], v[112:115], v[16:31]
    v_mfma_f32_32x32x16_bf16 v[32:47], v[124:127], v[116:119], v[32:47]
    v_mfma_f32_32x32x16_bf16 v[48:63], v[128:131], v[112:115], v[48:63]
    v_mfma_f32_32x32x16_bf16 v[64:79], v[128:131], v[116:119], v[64:79]
    s_nop 15
    v_sub_f32 v16, v16, v162
    v_sub_f32 v17, v17, v162
    v_sub_f32 v18, v18, v162
    v_sub_f32 v19, v19, v162
    v_sub_f32 v20, v20, v162
    v_sub_f32 v21, v21, v162
    v_sub_f32 v22, v22, v162
    v_sub_f32 v23, v23, v162
    v_sub_f32 v24, v24, v162
    v_sub_f32 v25, v25, v162
    v_sub_f32 v26, v26, v162
    v_sub_f32 v27, v27, v162
    v_sub_f32 v28, v28, v162
    v_sub_f32 v29, v29, v162
    v_sub_f32 v30, v30, v162
    v_sub_f32 v31, v31, v162
    v_sub_f32 v32, v32, v163
    v_sub_f32 v33, v33, v163
    v_sub_f32 v34, v34, v163
    v_sub_f32 v35, v35, v163
    v_sub_f32 v36, v36, v163
    v_sub_f32 v37, v37, v163
    v_sub_f32 v38, v38, v163
    v_sub_f32 v39, v39, v163
    v_sub_f32 v40, v40, v163
    v_sub_f32 v41, v41, v163
    v_sub_f32 v42, v42, v163
    v_sub_f32 v43, v43, v163
    v_sub_f32 v44, v44, v163
    v_sub_f32 v45, v45, v163
    v_sub_f32 v46, v46, v163
    v_sub_f32 v47, v47, v163
    v_sub_f32 v48, v48, v162
    v_sub_f32 v49, v49, v162
    v_sub_f32 v50, v50, v162
    v_sub_f32 v51, v51, v162
    v_sub_f32 v52, v52, v162
    v_sub_f32 v53, v53, v162
    v_sub_f32 v54, v54, v162
    v_sub_f32 v55, v55, v162
    v_sub_f32 v56, v56, v162
    v_sub_f32 v57, v57, v162
    v_sub_f32 v58, v58, v162
    v_sub_f32 v59, v59, v162
    v_sub_f32 v60, v60, v162
    v_sub_f32 v61, v61, v162
    v_sub_f32 v62, v62, v162
    v_sub_f32 v63, v63, v162
    v_sub_f32 v64, v64, v163
    v_sub_f32 v65, v65, v163
    v_sub_f32 v66, v66, v163
    v_sub_f32 v67, v67, v163
    v_sub_f32 v68, v68, v163
    v_sub_f32 v69, v69, v163
    v_sub_f32 v70, v70, v163
    v_sub_f32 v71, v71, v163
    v_sub_f32 v72, v72, v163
    v_sub_f32 v73, v73, v163
    v_sub_f32 v74, v74, v163
    v_sub_f32 v75, v75, v163
    v_sub_f32 v76, v76, v163
    v_sub_f32 v77, v77, v163
    v_sub_f32 v78, v78, v163
    v_sub_f32 v79, v79, v163
    v_exp_f32 v16, v16
    v_exp_f32 v17, v17
    v_exp_f32 v18, v18
    v_exp_f32 v19, v19
    v_exp_f32 v20, v20
    v_exp_f32 v21, v21
    v_exp_f32 v22, v22
    v_exp_f32 v23, v23
    v_exp_f32 v24, v24
    v_exp_f32 v25, v25
    v_exp_f32 v26, v26
    v_exp_f32 v27, v27
    v_exp_f32 v28, v28
    v_exp_f32 v29, v29
    v_exp_f32 v30, v30
    v_exp_f32 v31, v31
    v_exp_f32 v32, v32
    v_exp_f32 v33, v33
    v_exp_f32 v34, v34
    v_exp_f32 v35, v35
    v_exp_f32 v36, v36
    v_exp_f32 v37, v37
    v_exp_f32 v38, v38
    v_exp_f32 v39, v39
    v_exp_f32 v40, v40
    v_exp_f32 v41, v41
    v_exp_f32 v42, v42
    v_exp_f32 v43, v43
    v_exp_f32 v44, v44
    v_exp_f32 v45, v45
    v_exp_f32 v46, v46
    v_exp_f32 v47, v47
    v_exp_f32 v48, v48
    v_exp_f32 v49, v49
    v_exp_f32 v50, v50
    v_exp_f32 v51, v51
    v_exp_f32 v52, v52
    v_exp_f32 v53, v53
    v_exp_f32 v54, v54
    v_exp_f32 v55, v55
    v_exp_f32 v56, v56
    v_exp_f32 v57, v57
    v_exp_f32 v58, v58
    v_exp_f32 v59, v59
    v_exp_f32 v60, v60
    v_exp_f32 v61, v61
    v_exp_f32 v62, v62
    v_exp_f32 v63, v63
    v_exp_f32 v64, v64
    v_exp_f32 v65, v65
    v_exp_f32 v66, v66
    v_exp_f32 v67, v67
    v_exp_f32 v68, v68
    v_exp_f32 v69, v69
    v_exp_f32 v70, v70
    v_exp_f32 v71, v71
    v_exp_f32 v72, v72
    v_exp_f32 v73, v73
    v_exp_f32 v74, v74
    v_exp_f32 v75, v75
    v_exp_f32 v76, v76
    v_exp_f32 v77, v77
    v_exp_f32 v78, v78
    v_exp_f32 v79, v79
    s_nop 1
    v_smfmac_f32_32x32x32_bf16 v[80:95], v[132:135], v[16:23], v14
    v_smfmac_f32_32x32x32_bf16 v[80:95], v[140:143], v[24:31], v14
    v_smfmac_f32_32x32x32_bf16 v[96:111], v[132:135], v[32:39], v14
    v_smfmac_f32_32x32x32_bf16 v[96:111], v[140:143], v[40:47], v14
    v_smfmac_f32_32x32x32_bf16 v[80:95], v[136:139], v[48:55], v14
    v_smfmac_f32_32x32x32_bf16 v[80:95], v[144:147], v[56:63], v14
    v_smfmac_f32_32x32x32_bf16 v[96:111], v[136:139], v[64:71], v14
    v_smfmac_f32_32x32x32_bf16 v[96:111], v[144:147], v[72:79], v14
    v_add_u32 v164, 2304, v164
    v_add_u32 v165, 2816, v165
    v_add_u32 v166, 2816, v166
    v_add_u32 v167, 2816, v167
    v_add_u32 v168, 2816, v168
    v_add_u32 v169, 2816, v169
    s_add_u32 s3, s3, 1
    s_cmp_lt_u32 s3, 32
    s_cbranch_scc1 L_fb2
    s_nop 15
    s_branch L_epi
.section .rodata,"a"
.p2align 6
.amdhsa_kernel standalone__fused_io_aware_attn__prompt_kernel
  .amdhsa_next_free_vgpr 192
  .amdhsa_next_free_sgpr 88
  .amdhsa_accum_offset 192
  .amdhsa_group_segment_fixed_size 0
  .amdhsa_kernarg_size 48
  .amdhsa_user_sgpr_count 2
  .amdhsa_user_sgpr_kernarg_segment_ptr 1
  .amdhsa_system_sgpr_workgroup_id_x 1
  .amdhsa_float_denorm_mode_32 3
.end_amdhsa_kernel
```
